```python
import torch

def _softmax(x, axis=-1):
    return torch.softmax(x, dim=axis)
def _gelu(x):
    return torch.nn.functional.gelu(x, approximate="tanh")
def _silu(x):
    return torch.nn.functional.silu(x)
def _sigmoid(x):
    return torch.sigmoid(x)
def _layernorm(x, axis=-1, eps=1e-5):
    m = x.mean(dim=axis, keepdim=True)
    v = x.var(dim=axis, keepdim=True, unbiased=False)
    return (x - m) / torch.sqrt(v + eps)
def _scatter_add(tgt, idx, src, axis=0):
    return tgt.clone().index_add_(axis, idx, src)
def _segment_sum(src, seg, n):
    out = torch.zeros((n,) + src.shape[1:], dtype=src.dtype)
    return out.index_add_(0, seg, src)
def _pad(x, pw):
    flat = tuple(v for pair in reversed(pw) for v in pair)
    return torch.nn.functional.pad(x, flat)

kernel_name = 'sequential_preLN__ssm_conv_s4d__dense_activation_gelu__prompt'

def setup_inputs():

    _w = (lambda a: (lambda t: t.to(torch.bfloat16) if t.is_floating_point() else t)(torch.as_tensor(a)))
    def _A_setup():
        Bsz, L, D, N = 1, 2048, 448, 256
        return {
            "u": _w((lambda *s: torch.randn(*s, dtype=torch.bfloat16) * 0.05)(Bsz, L, D)),
            "log_A_real": _w((lambda *s: torch.randn(*s, dtype=torch.bfloat16) * 6.4)(D, N) * 0.5),
            "A_imag": _w((lambda *s: torch.randn(*s, dtype=torch.bfloat16) * 0.05)(D, N) * 3.14),
            "C_real": _w((lambda *s: torch.randn(*s, dtype=torch.bfloat16) * 0.05)(D, N) / N ** 0.5),
            "C_imag": _w((lambda *s: torch.randn(*s, dtype=torch.bfloat16) * 0.05)(D, N) / N ** 0.5),
            "log_dt": _w((lambda *s: torch.randn(*s, dtype=torch.bfloat16) * 0.05)(D) * 0.5 - 4.0),
            "D_skip": _w((lambda *s: torch.randn(*s, dtype=torch.bfloat16) * 0.05)(D)),
        }
    _A_in = _A_setup()

    def _B_setup():
        B, S, D, F = 1, 2048, 448, 1792
        return {
            "x": _w((lambda *s: torch.randn(*s, dtype=torch.bfloat16) * 0.05)(B, S, D)),
            "w1": _w((lambda *s: torch.randn(*s, dtype=torch.bfloat16) * 0.8)(D, F) * (D ** -0.5)),
            "b1": _w((lambda *s: torch.randn(*s, dtype=torch.bfloat16) * 0.2)(F) * 0.01),
            "w2": _w((lambda *s: torch.randn(*s, dtype=torch.bfloat16) * 0.2)(F, D) * (F ** -0.5)),
            "b2": _w((lambda *s: torch.randn(*s, dtype=torch.bfloat16) * 0.2)(D) * 0.01),
        }
    _B_in = _B_setup()

    return {
        "A_u": _A_in["u"],
        "A_log_A_real": _A_in["log_A_real"],
        "A_A_imag": _A_in["A_imag"],
        "A_C_real": _A_in["C_real"],
        "A_C_imag": _A_in["C_imag"],
        "A_log_dt": _A_in["log_dt"],
        "A_D_skip": _A_in["D_skip"],
        "B_x": _B_in["x"],
        "B_w1": _B_in["w1"],
        "B_b1": _B_in["b1"],
        "B_w2": _B_in["w2"],
        "B_b2": _B_in["b2"],
    }

def reference(A_u, A_log_A_real, A_A_imag, A_C_real, A_C_imag, A_log_dt, A_D_skip, B_x, B_w1, B_b1, B_w2, B_b2):
    def _A_ref(u, log_A_real, A_imag, C_real, C_imag, log_dt, D_skip):
        L = u.shape[1]
        dt = torch.exp(log_dt)
        A = -torch.exp(log_A_real) + 1j * A_imag
        C = (C_real + 1j * C_imag) * dt[:, None]
        pos = (lambda x, dt: x.to(dt))(torch.arange(L), log_dt.dtype)
        P = torch.exp((A * dt[:, None])[:, :, None] * pos[None, None, :])
        K = 2.0 * torch.einsum("dn,dnl->dl", C, P).real
        L2 = 2 * L
        u_t = (lambda x, *d: x.permute(*d))(u, 0, 2, 1)
        Kf = (lambda x, *a, **k: torch.fft.rfft(x.float(), *a, **k))(K, L2)
        Uf = (lambda x, *a, **k: torch.fft.rfft(x.float(), *a, **k))(u_t, L2)
        y = (lambda x, *a, **k: torch.fft.irfft(x, *a, **k).to(torch.bfloat16))(Uf * Kf[None, :, :], L2)[:, :, :L]
        y = (lambda x, *d: x.permute(*d))(y, 0, 2, 1)
        return y + u * D_skip[None, None, :]

    def _B_ref(x, w1, b1, w2, b2):
        h = torch.einsum("bsd,df->bsf", x, w1) + b1
        h = _gelu(h)
        return torch.einsum("bsf,fd->bsd", h, w2) + b2

    x = A_u
    h = x + _A_ref(_layernorm(x, axis=-1), A_log_A_real, A_A_imag, A_C_real, A_C_imag, A_log_dt, A_D_skip)
    h2 = h + _B_ref(_layernorm(h, axis=-1), B_w1, B_b1, B_w2, B_b2)
    return h2
```

```asm
; @launch kernel=k1_prep_kernel grid=(808,1,1) block=(256,1,1) lds=24576
; @launch kernel=k3_mlp_kernel grid=(256,1,1) block=(512,1,1) lds=151552
.amdgcn_target "amdgcn-amd-amdhsa--gfx950"
.text
.globl k1_prep_kernel
.p2align 8
.type k1_prep_kernel,@function
k1_prep_kernel:
    s_cmp_ge_u32 s2, 808
    s_cbranch_scc1 K1_exit
    s_cmp_ge_u32 s2, 8
    s_cbranch_scc1 K1_main0
    s_getpc_b64 s[4:5]
K1_pc:
    s_sub_u32 s4, s4, K1_pc-k1_prep_kernel
    s_subb_u32 s5, s5, 0
    v_lshlrev_b32 v1, 4, v0
    v_min_u32 v2, CODE_END-k1_prep_kernel-16, v1
    global_load_dwordx4 v[8:11], v2, s[4:5]
    v_add_u32 v1, 4096, v1
    v_min_u32 v2, CODE_END-k1_prep_kernel-16, v1
    global_load_dwordx4 v[12:15], v2, s[4:5]
    v_add_u32 v1, 4096, v1
    v_min_u32 v2, CODE_END-k1_prep_kernel-16, v1
    global_load_dwordx4 v[16:19], v2, s[4:5]
    v_add_u32 v1, 4096, v1
    v_min_u32 v2, CODE_END-k1_prep_kernel-16, v1
    global_load_dwordx4 v[20:23], v2, s[4:5]
    v_add_u32 v1, 4096, v1
    v_min_u32 v2, CODE_END-k1_prep_kernel-16, v1
    global_load_dwordx4 v[24:27], v2, s[4:5]
    v_add_u32 v1, 4096, v1
    v_min_u32 v2, CODE_END-k1_prep_kernel-16, v1
    global_load_dwordx4 v[28:31], v2, s[4:5]
    v_add_u32 v1, 4096, v1
    v_min_u32 v2, CODE_END-k1_prep_kernel-16, v1
    global_load_dwordx4 v[32:35], v2, s[4:5]
    v_add_u32 v1, 4096, v1
    s_waitcnt vmcnt(0)
    s_endpgm
K1_main0:
    s_sub_u32 s2, s2, 8
    s_load_dwordx16 s[16:31], s[0:1], 0
    s_load_dwordx8 s[32:39], s[0:1], 64
    s_load_dwordx2 s[40:41], s[0:1], 112
    s_cmp_lt_u32 s2, 128
    s_cbranch_scc1 K1_ln1
    s_cmp_lt_u32 s2, 576
    s_cbranch_scc1 K1_kgen
    s_cmp_lt_u32 s2, 772
    s_cbranch_scc1 K1_wp
    s_branch K1_cs
K1_exit:
    s_endpgm
K1_kgen:
    s_sub_u32 s2, s2, 128
    s_lshl_b32 s3, s2, 9
    v_lshlrev_b32 v1, 1, v0
    v_add_u32 v1, s3, v1
    s_lshl_b32 s4, s2, 1
    v_mov_b32 v7, s4
    s_waitcnt lgkmcnt(0)
    global_load_ushort v2, v1, s[18:19]
    global_load_ushort v3, v1, s[20:21]
    global_load_ushort v4, v1, s[22:23]
    global_load_ushort v5, v1, s[24:25]
    global_load_ushort v6, v7, s[26:27]
    v_lshrrev_b32 v46, 6, v0
    v_mul_u32_u24 v46, 4352, v46
    v_and_b32 v47, 63, v0
    v_lshl_add_u32 v44, v47, 2, v46
    v_and_b32 v8, 15, v0
    v_mul_u32_u24 v8, 272, v8
    v_lshrrev_b32 v9, 4, v47
    v_lshlrev_b32 v9, 4, v9
    v_add3_u32 v45, v46, v8, v9
    v_lshrrev_b32 v20, 4, v47
    v_and_b32 v21, 15, v47
    v_lshrrev_b32 v22, 1, v20
    v_lshlrev_b32 v22, 7, v22
    v_and_b32 v23, 1, v20
    v_lshl_add_u32 v22, v23, 2, v22
    v_lshl_add_u32 v22, v21, 3, v22
    v_lshl_add_u32 v100, v22, 2, v46
    v_cmp_gt_u32 vcc, 2, v20
    v_lshlrev_b32 v23, 6, v20
    v_add_u32 v23, 256, v23
    v_lshlrev_b32 v24, 2, v21
    v_lshlrev_b32 v25, 1, v21
    v_cndmask_b32 v24, v25, v24, vcc
    v_add_u32 v23, v23, v24
    v_cndmask_b32_e64 v25, 32, 2, vcc
    v_add_u32 v24, v23, v25
    v_lshl_add_u32 v101, v23, 2, v46
    v_lshl_add_u32 v102, v24, 2, v46
    v_lshl_add_u32 v25, v20, 6, v21
    v_add_u32 v25, 512, v25
    v_lshl_add_u32 v103, v25, 2, v46
    v_lshlrev_b32 v8, 3, v0
    v_cmp_gt_u32 vcc, 16, v0
    v_add_u32 v104, 0, v8
    v_add_u32 v105, 1, v8
    v_cvt_f32_u32 v10, v104
    v_cvt_f32_u32 v11, v105
    v_cvt_pk_bf16_f32 v10, v10, v11
    v_and_b32 v11, 0xffff, v10
    v_lshrrev_b32 v10, 16, v10
    v_subrev_u32 v11, 17024, v11
    v_subrev_u32 v10, 17024, v10
    v_cndmask_b32 v104, v11, v104, vcc
    v_cndmask_b32 v105, v10, v105, vcc
    v_add_u32 v106, 2, v8
    v_add_u32 v107, 3, v8
    v_cvt_f32_u32 v10, v106
    v_cvt_f32_u32 v11, v107
    v_cvt_pk_bf16_f32 v10, v10, v11
    v_and_b32 v11, 0xffff, v10
    v_lshrrev_b32 v10, 16, v10
    v_subrev_u32 v11, 17024, v11
    v_subrev_u32 v10, 17024, v10
    v_cndmask_b32 v106, v11, v106, vcc
    v_cndmask_b32 v107, v10, v107, vcc
    v_add_u32 v108, 4, v8
    v_add_u32 v109, 5, v8
    v_cvt_f32_u32 v10, v108
    v_cvt_f32_u32 v11, v109
    v_cvt_pk_bf16_f32 v10, v10, v11
    v_and_b32 v11, 0xffff, v10
    v_lshrrev_b32 v10, 16, v10
    v_subrev_u32 v11, 17024, v11
    v_subrev_u32 v10, 17024, v10
    v_cndmask_b32 v108, v11, v108, vcc
    v_cndmask_b32 v109, v10, v109, vcc
    v_add_u32 v110, 6, v8
    v_add_u32 v111, 7, v8
    v_cvt_f32_u32 v10, v110
    v_cvt_f32_u32 v11, v111
    v_cvt_pk_bf16_f32 v10, v10, v11
    v_and_b32 v11, 0xffff, v10
    v_lshrrev_b32 v10, 16, v10
    v_subrev_u32 v11, 17024, v11
    v_subrev_u32 v10, 17024, v10
    v_cndmask_b32 v110, v11, v110, vcc
    v_cndmask_b32 v111, v10, v111, vcc
    v_lshlrev_b32 v104, 2, v104
    v_lshlrev_b32 v105, 2, v105
    v_lshlrev_b32 v106, 2, v106
    v_lshlrev_b32 v107, 2, v107
    v_lshlrev_b32 v108, 2, v108
    v_lshlrev_b32 v109, 2, v109
    v_lshlrev_b32 v110, 2, v110
    v_lshlrev_b32 v111, 2, v111
    s_waitcnt vmcnt(0)
    v_lshlrev_b32 v6, 16, v6
    v_lshlrev_b32 v2, 16, v2
    v_lshlrev_b32 v3, 16, v3
    v_mul_f32 v8, 0x3fb8aa00, v6
    v_mul_f32 v12, 0x3fb8aa00, v2
    v_mul_f32 v9, 0x36a407db, v6
    v_exp_f32 v8, v8
    v_exp_f32 v12, v12
    v_mul_f32 v13, 0x36a407db, v2
    v_lshlrev_b32 v4, 16, v4
    v_lshlrev_b32 v5, 16, v5
    v_fma_f32 v8, v8, v9, v8
    v_fma_f32 v12, v12, v13, v12
    v_cvt_pk_bf16_f32 v8, v8, v8
    v_cvt_pk_bf16_f32 v12, v12, v12
    v_lshlrev_b32 v6, 16, v8
    v_lshlrev_b32 v2, 16, v12
    v_mul_f32 v11, v3, v6
    v_mul_f32 v10, v2, v6
    v_mul_f32 v4, v4, v6
    v_mul_f32 v11, 0x3e22f983, v11
    v_mul_f32 v10, 0xbfb8aa3b, v10
    v_mul_f32 v5, v5, v6
    v_mul_f32 v9, 0x3f800000, v11
    v_mul_f32 v13, 0x41000000, v11
    v_mul_f32 v43, 0x43000000, v11
    v_mul_f32 v8, 0x3f800000, v10
    v_fract_f32 v9, v9
    v_mul_f32 v12, 0x41000000, v10
    v_fract_f32 v13, v13
    v_mul_f32 v42, 0x43000000, v10
    v_fract_f32 v43, v43
    v_exp_f32 v8, v8
    v_cos_f32 v20, v9
    v_sin_f32 v21, v9
    v_exp_f32 v12, v12
    v_cos_f32 v64, v13
    v_sin_f32 v65, v13
    v_exp_f32 v42, v42
    v_cos_f32 v18, v43
    v_sin_f32 v19, v43
    v_add_f32 v34, v4, v4
    v_add_f32 v35, v5, v5
    v_mul_f32 v20, v8, v20
    v_mul_f32 v21, v8, v21
    v_add_f32 v1, |v34|, |v35|
    v_mul_f32 v64, v12, v64
    v_mul_f32 v65, v12, v65
    v_mul_f32 v18, v42, v18
    v_mul_f32 v19, v42, v19
    v_max_f32_dpp v1, v1, v1 row_shr:1 row_mask:0xf bank_mask:0xf bound_ctrl:0
    s_nop 1
    v_max_f32_dpp v1, v1, v1 row_shr:2 row_mask:0xf bank_mask:0xf bound_ctrl:0
    s_nop 1
    v_max_f32_dpp v1, v1, v1 row_shr:4 row_mask:0xf bank_mask:0xf bound_ctrl:0
    s_nop 1
    v_max_f32_dpp v1, v1, v1 row_shr:8 row_mask:0xf bank_mask:0xf bound_ctrl:0
    s_nop 1
    v_max_f32_dpp v1, v1, v1 row_bcast:15 row_mask:0xa bank_mask:0xf
    s_nop 1
    v_max_f32_dpp v1, v1, v1 row_bcast:31 row_mask:0xc bank_mask:0xf
    s_nop 0
    v_readlane_b32 s5, v1, 63
    s_nop 1
    v_frexp_exp_i32_f32 v1, s5
    v_mov_b32 v7, 100
    v_min_i32 v1, v1, v7
    v_mov_b32 v7, -100
    v_max_i32 v1, v1, v7
    v_sub_u32 v7, 0, v1
    v_ldexp_f32 v34, v34, v7
    v_ldexp_f32 v35, v35, v7
    v_ldexp_f32 v98, 1.0, v1
    v_lshrrev_b32 v7, 6, v0
    v_lshlrev_b32 v7, 2, v7
    ds_write_b32 v7, v1 offset:17408
    v_pk_mul_f32 v[118:119], v[64:65], v[64:65] op_sel_hi:[0,1]
    v_pk_fma_f32 v[66:67], v[64:65], v[64:65], v[118:119] op_sel:[1,1,0] op_sel_hi:[1,0,1] neg_lo:[1,0,0]
    v_pk_mul_f32 v[126:127], v[66:67], v[66:67] op_sel_hi:[0,1]
    v_pk_mul_f32 v[122:123], v[66:67], v[64:65] op_sel_hi:[0,1]
    v_pk_fma_f32 v[70:71], v[66:67], v[66:67], v[126:127] op_sel:[1,1,0] op_sel_hi:[1,0,1] neg_lo:[1,0,0]
    v_pk_mul_f32 v[126:127], v[20:21], v[20:21] op_sel_hi:[0,1]
    v_pk_fma_f32 v[68:69], v[66:67], v[64:65], v[122:123] op_sel:[1,1,0] op_sel_hi:[1,0,1] neg_lo:[1,0,0]
    v_pk_mul_f32 v[118:119], v[70:71], v[66:67] op_sel_hi:[0,1]
    v_pk_fma_f32 v[22:23], v[20:21], v[20:21], v[126:127] op_sel:[1,1,0] op_sel_hi:[1,0,1] neg_lo:[1,0,0]
    v_pk_mul_f32 v[114:115], v[70:71], v[64:65] op_sel_hi:[0,1]
    v_pk_fma_f32 v[74:75], v[70:71], v[66:67], v[118:119] op_sel:[1,1,0] op_sel_hi:[1,0,1] neg_lo:[1,0,0]
    v_pk_mul_f32 v[118:119], v[22:23], v[22:23] op_sel_hi:[0,1]
    v_pk_mul_f32 v[122:123], v[70:71], v[68:69] op_sel_hi:[0,1]
    v_pk_fma_f32 v[72:73], v[70:71], v[64:65], v[114:115] op_sel:[1,1,0] op_sel_hi:[1,0,1] neg_lo:[1,0,0]
    v_pk_fma_f32 v[26:27], v[22:23], v[22:23], v[118:119] op_sel:[1,1,0] op_sel_hi:[1,0,1] neg_lo:[1,0,0]
    v_pk_fma_f32 v[76:77], v[70:71], v[68:69], v[122:123] op_sel:[1,1,0] op_sel_hi:[1,0,1] neg_lo:[1,0,0]
    v_pk_mul_f32 v[114:115], v[22:23], v[20:21] op_sel_hi:[0,1]
    v_pk_mul_f32 v[126:127], v[26:27], v[22:23] op_sel_hi:[0,1]
    v_pk_mul_f32 v[122:123], v[26:27], v[20:21] op_sel_hi:[0,1]
    v_pk_fma_f32 v[24:25], v[22:23], v[20:21], v[114:115] op_sel:[1,1,0] op_sel_hi:[1,0,1] neg_lo:[1,0,0]
    v_pk_fma_f32 v[30:31], v[26:27], v[22:23], v[126:127] op_sel:[1,1,0] op_sel_hi:[1,0,1] neg_lo:[1,0,0]
    v_pk_mul_f32 v[126:127], v[18:19], v[18:19] op_sel_hi:[0,1]
    v_pk_fma_f32 v[28:29], v[26:27], v[20:21], v[122:123] op_sel:[1,1,0] op_sel_hi:[1,0,1] neg_lo:[1,0,0]
    v_pk_mul_f32 v[122:123], v[34:35], v[18:19] op_sel_hi:[0,1]
    v_pk_fma_f32 v[42:43], v[18:19], v[18:19], v[126:127] op_sel:[1,1,0] op_sel_hi:[1,0,1] neg_lo:[1,0,0]
    v_pk_mul_f32 v[114:115], v[26:27], v[24:25] op_sel_hi:[0,1]
    v_pk_fma_f32 v[36:37], v[34:35], v[18:19], v[122:123] op_sel:[1,1,0] op_sel_hi:[1,0,1] neg_lo:[1,0,0]
    v_pk_mul_f32 v[122:123], v[42:43], v[42:43] op_sel_hi:[0,1]
    v_pk_fma_f32 v[32:33], v[26:27], v[24:25], v[114:115] op_sel:[1,1,0] op_sel_hi:[1,0,1] neg_lo:[1,0,0]
    v_pk_mul_f32 v[114:115], v[34:35], v[42:43] op_sel_hi:[0,1]
    v_pk_fma_f32 v[14:15], v[42:43], v[42:43], v[122:123] op_sel:[1,1,0] op_sel_hi:[1,0,1] neg_lo:[1,0,0]
    v_pk_mul_f32 v[118:119], v[70:71], v[70:71] op_sel_hi:[0,1]
    v_pk_fma_f32 v[38:39], v[34:35], v[42:43], v[114:115] op_sel:[1,1,0] op_sel_hi:[1,0,1] neg_lo:[1,0,0]
    v_pk_mul_f32 v[114:115], v[14:15], v[14:15] op_sel_hi:[0,1]
    v_pk_fma_f32 v[78:79], v[70:71], v[70:71], v[118:119] op_sel:[1,1,0] op_sel_hi:[1,0,1] neg_lo:[1,0,0]
    v_pk_mul_f32 v[118:119], v[36:37], v[42:43] op_sel_hi:[0,1]
    v_pk_fma_f32 v[18:19], v[14:15], v[14:15], v[114:115] op_sel:[1,1,0] op_sel_hi:[1,0,1] neg_lo:[1,0,0]
    v_pk_mul_f32 v[126:127], v[14:15], v[26:27] op_sel_hi:[0,1]
    v_pk_fma_f32 v[40:41], v[36:37], v[42:43], v[118:119] op_sel:[1,1,0] op_sel_hi:[1,0,1] neg_lo:[1,0,0]
    v_pk_mul_f32 v[118:119], v[18:19], v[14:15] op_sel_hi:[0,1]
    v_pk_fma_f32 v[16:17], v[14:15], v[26:27], v[126:127] op_sel:[1,1,0] op_sel_hi:[1,0,1] neg_lo:[1,0,0]
    v_pk_mul_f32 v[122:123], v[18:19], v[18:19] op_sel_hi:[0,1]
    v_mov_b32 v126, 0x3c00
    v_pk_fma_f32 v[42:43], v[18:19], v[14:15], v[118:119] op_sel:[1,1,0] op_sel_hi:[1,0,1] neg_lo:[1,0,0]
    v_cvt_pk_f16_f32 v114, v64, v65
    v_pk_fma_f32 v[96:97], v[18:19], v[18:19], v[122:123] op_sel:[1,1,0] op_sel_hi:[1,0,1] neg_lo:[1,0,0]
    v_cvt_pk_f16_f32 v118, v66, v67
    ds_write_b32 v44, v126
    v_cvt_pk_f16_f32 v122, v68, v69
    ds_write_b32 v44, v114 offset:272
    v_cvt_pk_f16_f32 v126, v70, v71
    ds_write_b32 v44, v118 offset:544
    v_cvt_pk_f16_f32 v114, v72, v73
    ds_write_b32 v44, v122 offset:816
    v_cvt_pk_f16_f32 v118, v74, v75
    ds_write_b32 v44, v126 offset:1088
    v_cvt_pk_f16_f32 v122, v76, v77
    ds_write_b32 v44, v114 offset:1360
    ds_write_b32 v44, v118 offset:1632
    v_pk_mul_f32 v[114:115], v[78:79], v[64:65] op_sel_hi:[0,1]
    ds_write_b32 v44, v122 offset:1904
    v_pk_mul_f32 v[118:119], v[78:79], v[66:67] op_sel_hi:[0,1]
    v_pk_mul_f32 v[122:123], v[78:79], v[68:69] op_sel_hi:[0,1]
    v_pk_fma_f32 v[112:113], v[78:79], v[64:65], v[114:115] op_sel:[1,1,0] op_sel_hi:[1,0,1] neg_lo:[1,0,0]
    v_pk_fma_f32 v[116:117], v[78:79], v[66:67], v[118:119] op_sel:[1,1,0] op_sel_hi:[1,0,1] neg_lo:[1,0,0]
    v_cvt_pk_f16_f32 v126, v78, v79
    v_pk_fma_f32 v[120:121], v[78:79], v[68:69], v[122:123] op_sel:[1,1,0] op_sel_hi:[1,0,1] neg_lo:[1,0,0]
    v_cvt_pk_f16_f32 v114, v112, v113
    v_cvt_pk_f16_f32 v118, v116, v117
    ds_write_b32 v44, v126 offset:2176
    v_cvt_pk_f16_f32 v122, v120, v121
    ds_write_b32 v44, v114 offset:2448
    v_pk_mul_f32 v[126:127], v[78:79], v[70:71] op_sel_hi:[0,1]
    ds_write_b32 v44, v118 offset:2720
    v_pk_mul_f32 v[114:115], v[78:79], v[72:73] op_sel_hi:[0,1]
    ds_write_b32 v44, v122 offset:2992
    v_pk_mul_f32 v[118:119], v[78:79], v[74:75] op_sel_hi:[0,1]
    v_pk_fma_f32 v[124:125], v[78:79], v[70:71], v[126:127] op_sel:[1,1,0] op_sel_hi:[1,0,1] neg_lo:[1,0,0]
    v_pk_mul_f32 v[122:123], v[78:79], v[76:77] op_sel_hi:[0,1]
    v_pk_fma_f32 v[112:113], v[78:79], v[72:73], v[114:115] op_sel:[1,1,0] op_sel_hi:[1,0,1] neg_lo:[1,0,0]
    v_pk_fma_f32 v[116:117], v[78:79], v[74:75], v[118:119] op_sel:[1,1,0] op_sel_hi:[1,0,1] neg_lo:[1,0,0]
    v_cvt_pk_f16_f32 v126, v124, v125
    v_pk_fma_f32 v[120:121], v[78:79], v[76:77], v[122:123] op_sel:[1,1,0] op_sel_hi:[1,0,1] neg_lo:[1,0,0]
    v_cvt_pk_f16_f32 v114, v112, v113
    v_cvt_pk_f16_f32 v118, v116, v117
    ds_write_b32 v44, v126 offset:3264
    v_cvt_pk_f16_f32 v122, v120, v121
    ds_write_b32 v44, v114 offset:3536
    ds_write_b32 v44, v118 offset:3808
    v_pk_mul_f32 v[114:115], v[34:35], v[20:21] op_sel_hi:[0,1]
    ds_write_b32 v44, v122 offset:4080
    v_pk_mul_f32 v[118:119], v[34:35], v[22:23] op_sel_hi:[0,1]
    v_pk_mul_f32 v[122:123], v[34:35], v[24:25] op_sel_hi:[0,1]
    v_pk_fma_f32 v[112:113], v[34:35], v[20:21], v[114:115] op_sel:[1,1,0] op_sel_hi:[1,0,1] neg_lo:[1,0,0]
    ds_read_b128 v[48:51], v45 offset:0
    v_pk_fma_f32 v[116:117], v[34:35], v[22:23], v[118:119] op_sel:[1,1,0] op_sel_hi:[1,0,1] neg_lo:[1,0,0]
    ds_read_b128 v[52:55], v45 offset:64
    v_cvt_pk_f16_f32 v126, v34, -v35
    v_pk_fma_f32 v[120:121], v[34:35], v[24:25], v[122:123] op_sel:[1,1,0] op_sel_hi:[1,0,1] neg_lo:[1,0,0]
    ds_read_b128 v[56:59], v45 offset:128
    v_cvt_pk_f16_f32 v114, v112, -v113
    ds_read_b128 v[60:63], v45 offset:192
    v_cvt_pk_f16_f32 v118, v116, -v117
    ds_write_b32 v44, v126 offset:0
    v_cvt_pk_f16_f32 v122, v120, -v121
    ds_write_b32 v44, v114 offset:272
    v_pk_mul_f32 v[126:127], v[34:35], v[26:27] op_sel_hi:[0,1]
    ds_write_b32 v44, v118 offset:544
    v_pk_mul_f32 v[114:115], v[34:35], v[28:29] op_sel_hi:[0,1]
    ds_write_b32 v44, v122 offset:816
    v_pk_mul_f32 v[118:119], v[34:35], v[30:31] op_sel_hi:[0,1]
    v_pk_fma_f32 v[124:125], v[34:35], v[26:27], v[126:127] op_sel:[1,1,0] op_sel_hi:[1,0,1] neg_lo:[1,0,0]
    v_pk_mul_f32 v[122:123], v[34:35], v[32:33] op_sel_hi:[0,1]
    v_pk_fma_f32 v[112:113], v[34:35], v[28:29], v[114:115] op_sel:[1,1,0] op_sel_hi:[1,0,1] neg_lo:[1,0,0]
    v_pk_fma_f32 v[116:117], v[34:35], v[30:31], v[118:119] op_sel:[1,1,0] op_sel_hi:[1,0,1] neg_lo:[1,0,0]
    v_cvt_pk_f16_f32 v126, v124, -v125
    v_pk_fma_f32 v[120:121], v[34:35], v[32:33], v[122:123] op_sel:[1,1,0] op_sel_hi:[1,0,1] neg_lo:[1,0,0]
    v_cvt_pk_f16_f32 v114, v112, -v113
    v_cvt_pk_f16_f32 v118, v116, -v117
    ds_write_b32 v44, v126 offset:1088
    v_cvt_pk_f16_f32 v122, v120, -v121
    ds_write_b32 v44, v114 offset:1360
    ds_write_b32 v44, v118 offset:1632
    v_pk_mul_f32 v[114:115], v[36:37], v[20:21] op_sel_hi:[0,1]
    ds_write_b32 v44, v122 offset:1904
    v_pk_mul_f32 v[118:119], v[36:37], v[22:23] op_sel_hi:[0,1]
    v_pk_mul_f32 v[122:123], v[36:37], v[24:25] op_sel_hi:[0,1]
    v_pk_fma_f32 v[112:113], v[36:37], v[20:21], v[114:115] op_sel:[1,1,0] op_sel_hi:[1,0,1] neg_lo:[1,0,0]
    v_pk_fma_f32 v[116:117], v[36:37], v[22:23], v[118:119] op_sel:[1,1,0] op_sel_hi:[1,0,1] neg_lo:[1,0,0]
    v_cvt_pk_f16_f32 v126, v36, -v37
    v_pk_fma_f32 v[120:121], v[36:37], v[24:25], v[122:123] op_sel:[1,1,0] op_sel_hi:[1,0,1] neg_lo:[1,0,0]
    v_cvt_pk_f16_f32 v114, v112, -v113
    v_cvt_pk_f16_f32 v118, v116, -v117
    ds_write_b32 v44, v126 offset:2176
    v_cvt_pk_f16_f32 v122, v120, -v121
    ds_write_b32 v44, v114 offset:2448
    v_pk_mul_f32 v[126:127], v[36:37], v[26:27] op_sel_hi:[0,1]
    ds_write_b32 v44, v118 offset:2720
    v_pk_mul_f32 v[114:115], v[36:37], v[28:29] op_sel_hi:[0,1]
    ds_write_b32 v44, v122 offset:2992
    v_pk_mul_f32 v[118:119], v[36:37], v[30:31] op_sel_hi:[0,1]
    v_pk_fma_f32 v[124:125], v[36:37], v[26:27], v[126:127] op_sel:[1,1,0] op_sel_hi:[1,0,1] neg_lo:[1,0,0]
    v_pk_mul_f32 v[122:123], v[36:37], v[32:33] op_sel_hi:[0,1]
    v_pk_fma_f32 v[112:113], v[36:37], v[28:29], v[114:115] op_sel:[1,1,0] op_sel_hi:[1,0,1] neg_lo:[1,0,0]
    v_pk_fma_f32 v[116:117], v[36:37], v[30:31], v[118:119] op_sel:[1,1,0] op_sel_hi:[1,0,1] neg_lo:[1,0,0]
    v_cvt_pk_f16_f32 v126, v124, -v125
    v_pk_fma_f32 v[120:121], v[36:37], v[32:33], v[122:123] op_sel:[1,1,0] op_sel_hi:[1,0,1] neg_lo:[1,0,0]
    v_cvt_pk_f16_f32 v114, v112, -v113
    v_cvt_pk_f16_f32 v118, v116, -v117
    ds_write_b32 v44, v126 offset:3264
    v_cvt_pk_f16_f32 v122, v120, -v121
    ds_write_b32 v44, v114 offset:3536
    ds_write_b32 v44, v118 offset:3808
    v_pk_mul_f32 v[114:115], v[38:39], v[22:23] op_sel_hi:[0,1]
    ds_write_b32 v44, v122 offset:4080
    v_pk_mul_f32 v[118:119], v[38:39], v[26:27] op_sel_hi:[0,1]
    v_pk_mul_f32 v[122:123], v[38:39], v[30:31] op_sel_hi:[0,1]
    v_pk_fma_f32 v[112:113], v[38:39], v[22:23], v[114:115] op_sel:[1,1,0] op_sel_hi:[1,0,1] neg_lo:[1,0,0]
    ds_read_b128 v[80:83], v45 offset:0
    v_pk_fma_f32 v[116:117], v[38:39], v[26:27], v[118:119] op_sel:[1,1,0] op_sel_hi:[1,0,1] neg_lo:[1,0,0]
    ds_read_b128 v[84:87], v45 offset:64
    v_cvt_pk_f16_f32 v126, v38, -v39
    v_pk_fma_f32 v[120:121], v[38:39], v[30:31], v[122:123] op_sel:[1,1,0] op_sel_hi:[1,0,1] neg_lo:[1,0,0]
    ds_read_b128 v[88:91], v45 offset:128
    v_cvt_pk_f16_f32 v114, v112, -v113
    ds_read_b128 v[92:95], v45 offset:192
    v_cvt_pk_f16_f32 v118, v116, -v117
    ds_write_b32 v44, v126 offset:0
    v_cvt_pk_f16_f32 v122, v120, -v121
    ds_write_b32 v44, v114 offset:272
    ds_write_b32 v44, v118 offset:544
    v_pk_mul_f32 v[114:115], v[40:41], v[22:23] op_sel_hi:[0,1]
    ds_write_b32 v44, v122 offset:816
    v_pk_mul_f32 v[118:119], v[40:41], v[26:27] op_sel_hi:[0,1]
    v_pk_mul_f32 v[122:123], v[40:41], v[30:31] op_sel_hi:[0,1]
    v_pk_fma_f32 v[112:113], v[40:41], v[22:23], v[114:115] op_sel:[1,1,0] op_sel_hi:[1,0,1] neg_lo:[1,0,0]
    v_pk_fma_f32 v[116:117], v[40:41], v[26:27], v[118:119] op_sel:[1,1,0] op_sel_hi:[1,0,1] neg_lo:[1,0,0]
    v_cvt_pk_f16_f32 v126, v40, -v41
    v_pk_fma_f32 v[120:121], v[40:41], v[30:31], v[122:123] op_sel:[1,1,0] op_sel_hi:[1,0,1] neg_lo:[1,0,0]
    v_cvt_pk_f16_f32 v114, v112, -v113
    v_cvt_pk_f16_f32 v118, v116, -v117
    ds_write_b32 v44, v126 offset:1088
    v_cvt_pk_f16_f32 v122, v120, -v121
    ds_write_b32 v44, v114 offset:1360
    ds_write_b32 v44, v118 offset:1632
    ds_write_b32 v44, v122 offset:1904
    s_waitcnt lgkmcnt(8)
    v_pk_mul_f32 v[126:127], v[34:35], v[14:15] op_sel_hi:[0,1]
    v_pk_mul_f32 v[114:115], v[34:35], v[16:17] op_sel_hi:[0,1]
    v_pk_mul_f32 v[118:119], v[36:37], v[14:15] op_sel_hi:[0,1]
    v_pk_fma_f32 v[124:125], v[34:35], v[14:15], v[126:127] op_sel:[1,1,0] op_sel_hi:[1,0,1] neg_lo:[1,0,0]
    v_pk_mul_f32 v[122:123], v[36:37], v[16:17] op_sel_hi:[0,1]
    v_pk_fma_f32 v[112:113], v[34:35], v[16:17], v[114:115] op_sel:[1,1,0] op_sel_hi:[1,0,1] neg_lo:[1,0,0]
    v_pk_fma_f32 v[116:117], v[36:37], v[14:15], v[118:119] op_sel:[1,1,0] op_sel_hi:[1,0,1] neg_lo:[1,0,0]
    v_cvt_pk_f16_f32 v126, v124, -v125
    v_pk_fma_f32 v[120:121], v[36:37], v[16:17], v[122:123] op_sel:[1,1,0] op_sel_hi:[1,0,1] neg_lo:[1,0,0]
    v_cvt_pk_f16_f32 v114, v112, -v113
    v_cvt_pk_f16_f32 v118, v116, -v117
    ds_write_b32 v44, v126 offset:2176
    v_cvt_pk_f16_f32 v122, v120, -v121
    ds_write_b32 v44, v114 offset:2448
    v_pk_mul_f32 v[126:127], v[38:39], v[14:15] op_sel_hi:[0,1]
    ds_write_b32 v44, v118 offset:2720
    v_pk_mul_f32 v[114:115], v[38:39], v[16:17] op_sel_hi:[0,1]
    v_mfma_f32_16x16x32_f16 v[2:5], v[80:83], v[48:51], 0
    ds_write_b32 v44, v122 offset:2992
    v_pk_mul_f32 v[118:119], v[40:41], v[14:15] op_sel_hi:[0,1]
    v_pk_fma_f32 v[124:125], v[38:39], v[14:15], v[126:127] op_sel:[1,1,0] op_sel_hi:[1,0,1] neg_lo:[1,0,0]
    v_pk_mul_f32 v[122:123], v[40:41], v[16:17] op_sel_hi:[0,1]
    v_pk_fma_f32 v[112:113], v[38:39], v[16:17], v[114:115] op_sel:[1,1,0] op_sel_hi:[1,0,1] neg_lo:[1,0,0]
    v_pk_fma_f32 v[116:117], v[40:41], v[14:15], v[118:119] op_sel:[1,1,0] op_sel_hi:[1,0,1] neg_lo:[1,0,0]
    v_cvt_pk_f16_f32 v126, v124, -v125
    v_pk_fma_f32 v[120:121], v[40:41], v[16:17], v[122:123] op_sel:[1,1,0] op_sel_hi:[1,0,1] neg_lo:[1,0,0]
    v_mfma_f32_16x16x32_f16 v[2:5], v[84:87], v[52:55], v[2:5]
    v_cvt_pk_f16_f32 v114, v112, -v113
    v_cvt_pk_f16_f32 v118, v116, -v117
    ds_write_b32 v44, v126 offset:3264
    v_cvt_pk_f16_f32 v122, v120, -v121
    ds_write_b32 v44, v114 offset:3536
    v_pk_mul_f32 v[126:127], v[34:35], v[18:19] op_sel_hi:[0,1]
    ds_write_b32 v44, v118 offset:3808
    v_pk_mul_f32 v[114:115], v[36:37], v[18:19] op_sel_hi:[0,1]
    v_mfma_f32_16x16x32_f16 v[2:5], v[88:91], v[56:59], v[2:5]
    ds_write_b32 v44, v122 offset:4080
    v_pk_mul_f32 v[118:119], v[38:39], v[18:19] op_sel_hi:[0,1]
    v_pk_fma_f32 v[124:125], v[34:35], v[18:19], v[126:127] op_sel:[1,1,0] op_sel_hi:[1,0,1] neg_lo:[1,0,0]
    v_pk_mul_f32 v[122:123], v[40:41], v[18:19] op_sel_hi:[0,1]
    v_pk_fma_f32 v[112:113], v[36:37], v[18:19], v[114:115] op_sel:[1,1,0] op_sel_hi:[1,0,1] neg_lo:[1,0,0]
    ds_read_b128 v[80:83], v45 offset:0
    v_pk_fma_f32 v[116:117], v[38:39], v[18:19], v[118:119] op_sel:[1,1,0] op_sel_hi:[1,0,1] neg_lo:[1,0,0]
    ds_read_b128 v[84:87], v45 offset:64
    v_cvt_pk_f16_f32 v126, v124, -v125
    v_pk_fma_f32 v[120:121], v[40:41], v[18:19], v[122:123] op_sel:[1,1,0] op_sel_hi:[1,0,1] neg_lo:[1,0,0]
    v_mfma_f32_16x16x32_f16 v[2:5], v[92:95], v[60:63], v[2:5]
    ds_read_b128 v[88:91], v45 offset:128
    v_cvt_pk_f16_f32 v114, v112, -v113
    ds_read_b128 v[92:95], v45 offset:192
    v_cvt_pk_f16_f32 v118, v116, -v117
    ds_write_b32 v44, v126 offset:0
    v_cvt_pk_f16_f32 v122, v120, -v121
    ds_write_b32 v44, v114 offset:272
    v_pk_mul_f32 v[126:127], v[34:35], v[42:43] op_sel_hi:[0,1]
    ds_write_b32 v44, v118 offset:544
    v_pk_mul_f32 v[114:115], v[36:37], v[42:43] op_sel_hi:[0,1]
    ds_write_b32 v44, v122 offset:816
    v_pk_mul_f32 v[118:119], v[38:39], v[42:43] op_sel_hi:[0,1]
    v_pk_fma_f32 v[124:125], v[34:35], v[42:43], v[126:127] op_sel:[1,1,0] op_sel_hi:[1,0,1] neg_lo:[1,0,0]
    v_pk_mul_f32 v[122:123], v[40:41], v[42:43] op_sel_hi:[0,1]
    v_pk_fma_f32 v[112:113], v[36:37], v[42:43], v[114:115] op_sel:[1,1,0] op_sel_hi:[1,0,1] neg_lo:[1,0,0]
    v_pk_fma_f32 v[116:117], v[38:39], v[42:43], v[118:119] op_sel:[1,1,0] op_sel_hi:[1,0,1] neg_lo:[1,0,0]
    v_cvt_pk_f16_f32 v126, v124, -v125
    v_pk_fma_f32 v[120:121], v[40:41], v[42:43], v[122:123] op_sel:[1,1,0] op_sel_hi:[1,0,1] neg_lo:[1,0,0]
    v_cvt_pk_f16_f32 v114, v112, -v113
    v_cvt_pk_f16_f32 v118, v116, -v117
    ds_write_b32 v44, v126 offset:1088
    v_cvt_pk_f16_f32 v122, v120, -v121
    ds_write_b32 v44, v114 offset:1360
    ds_write_b32 v44, v118 offset:1632
    ds_write_b32 v44, v122 offset:1904
    s_waitcnt lgkmcnt(8)
    v_mfma_f32_16x16x32_f16 v[6:9], v[80:83], v[48:51], 0
    v_pk_mul_f32 v[126:127], v[34:35], v[96:97] op_sel_hi:[0,1]
    v_mul_f32 v2, v98, v2
    v_mul_f32 v3, v98, v3
    v_pk_fma_f32 v[124:125], v[34:35], v[96:97], v[126:127] op_sel:[1,1,0] op_sel_hi:[1,0,1] neg_lo:[1,0,0]
    v_mfma_f32_16x16x32_f16 v[6:9], v[84:87], v[52:55], v[6:9]
    v_mul_f32 v4, v98, v4
    v_cvt_pk_f16_f32 v126, v124, -v125
    v_mul_f32 v5, v98, v5
    v_mfma_f32_16x16x32_f16 v[6:9], v[88:91], v[56:59], v[6:9]
    ds_write_b32 v44, v126 offset:2176
    ds_read_b128 v[80:83], v45 offset:0
    ds_read_b128 v[84:87], v45 offset:64
    ds_read_b128 v[88:91], v45 offset:128
    v_mfma_f32_16x16x32_f16 v[6:9], v[92:95], v[60:63], v[6:9]
    ds_read_b128 v[92:95], v45 offset:192
    s_waitcnt lgkmcnt(0)
    v_mfma_f32_16x16x32_f16 v[10:13], v[80:83], v[48:51], 0
    v_mfma_f32_16x16x32_f16 v[10:13], v[84:87], v[52:55], v[10:13]
    v_mfma_f32_16x16x32_f16 v[10:13], v[88:91], v[56:59], v[10:13]
    v_mfma_f32_16x16x32_f16 v[10:13], v[92:95], v[60:63], v[10:13]
    s_nop 1
    v_mul_f32 v6, v98, v6
    v_mul_f32 v7, v98, v7
    v_mul_f32 v8, v98, v8
    v_mul_f32 v9, v98, v9
    ds_write_b128 v100, v[2:5]
    ds_write_b64 v101, v[6:7]
    ds_write_b64 v102, v[8:9]
    v_mul_f32 v10, v98, v10
    v_mul_f32 v11, v98, v11
    v_mul_f32 v12, v98, v12
    v_mul_f32 v13, v98, v13
    ds_write_b32 v103, v10 offset:0
    ds_write_b32 v103, v11 offset:64
    ds_write_b32 v103, v12 offset:128
    ds_write_b32 v103, v13 offset:192
    s_mul_i32 s6, s2, 4160
    s_add_u32 s6, s6, 5701632
    v_lshl_add_u32 v8, v0, 4, s6
    v_mov_b32 v3, 0
    s_waitcnt lgkmcnt(0)
    s_barrier
    ds_read_b128 v[4:7], v3 offset:17408
    ds_read_b32 v48, v104 offset:0
    ds_read_b32 v49, v104 offset:4352
    ds_read_b32 v50, v104 offset:8704
    ds_read_b32 v51, v104 offset:13056
    ds_read_b32 v52, v105 offset:0
    ds_read_b32 v53, v105 offset:4352
    ds_read_b32 v54, v105 offset:8704
    ds_read_b32 v55, v105 offset:13056
    ds_read_b32 v56, v106 offset:0
    ds_read_b32 v57, v106 offset:4352
    ds_read_b32 v58, v106 offset:8704
    ds_read_b32 v59, v106 offset:13056
    ds_read_b32 v60, v107 offset:0
    ds_read_b32 v61, v107 offset:4352
    ds_read_b32 v62, v107 offset:8704
    ds_read_b32 v63, v107 offset:13056
    ds_read_b32 v64, v108 offset:0
    ds_read_b32 v65, v108 offset:4352
    ds_read_b32 v66, v108 offset:8704
    ds_read_b32 v67, v108 offset:13056
    ds_read_b32 v68, v109 offset:0
    ds_read_b32 v69, v109 offset:4352
    ds_read_b32 v70, v109 offset:8704
    ds_read_b32 v71, v109 offset:13056
    ds_read_b32 v72, v110 offset:0
    ds_read_b32 v73, v110 offset:4352
    ds_read_b32 v74, v110 offset:8704
    ds_read_b32 v75, v110 offset:13056
    ds_read_b32 v76, v111 offset:0
    ds_read_b32 v77, v111 offset:4352
    ds_read_b32 v78, v111 offset:8704
    ds_read_b32 v79, v111 offset:13056
    s_waitcnt lgkmcnt(15)
    v_max3_i32 v4, v4, v5, v6
    v_max_i32 v5, v4, v7
    v_sub_u32 v6, 7, v5
    v_ldexp_f32 v6, 1.0, v6
    v_subrev_u32 v7, 7, v5
    v_ldexp_f32 v7, 1.0, v7
    s_waitcnt lgkmcnt(15)
    v_add_f32 v48, v48, v49
    v_add_f32 v50, v50, v51
    v_add_f32 v48, v48, v50
    v_mul_f32 v30, v6, v48
    s_waitcnt lgkmcnt(15)
    v_add_f32 v52, v52, v53
    v_add_f32 v54, v54, v55
    v_add_f32 v52, v52, v54
    v_mul_f32 v31, v6, v52
    s_waitcnt lgkmcnt(15)
    v_add_f32 v56, v56, v57
    v_add_f32 v58, v58, v59
    v_add_f32 v56, v56, v58
    v_mul_f32 v32, v6, v56
    s_waitcnt lgkmcnt(15)
    v_add_f32 v60, v60, v61
    v_add_f32 v62, v62, v63
    v_add_f32 v60, v60, v62
    v_mul_f32 v33, v6, v60
    s_waitcnt lgkmcnt(12)
    v_add_f32 v64, v64, v65
    v_add_f32 v66, v66, v67
    v_add_f32 v64, v64, v66
    v_mul_f32 v34, v6, v64
    s_waitcnt lgkmcnt(8)
    v_add_f32 v68, v68, v69
    v_add_f32 v70, v70, v71
    v_add_f32 v68, v68, v70
    v_mul_f32 v35, v6, v68
    s_waitcnt lgkmcnt(4)
    v_add_f32 v72, v72, v73
    v_add_f32 v74, v74, v75
    v_add_f32 v72, v72, v74
    v_mul_f32 v36, v6, v72
    s_waitcnt lgkmcnt(0)
    v_add_f32 v76, v76, v77
    v_add_f32 v78, v78, v79
    v_add_f32 v76, v76, v78
    v_mul_f32 v37, v6, v76
    v_cvt_pk_f16_f32 v40, v30, v31
    v_cvt_pk_f16_f32 v41, v32, v33
    v_cvt_pk_f16_f32 v42, v34, v35
    v_cvt_pk_f16_f32 v43, v36, v37
    global_store_dwordx4 v8, v[40:43], s[40:41] offset:0 sc0 sc1
    v_mov_b32 v9, s6
    v_add_u32 v9, 4096, v9
    v_cmp_eq_u32 vcc, 0, v0
    s_nop 0
    s_and_saveexec_b64 s[12:13], vcc
    s_cbranch_execz K1_kg_s2
    global_store_dword v9, v7, s[40:41] sc0 sc1
K1_kg_s2:
    s_mov_b64 exec, s[12:13]
    s_endpgm
K1_ln1:
    v_lshrrev_b32 v1, 6, v0
    s_and_b32 s5, s2, 7
    v_readfirstlane_b32 s4, v1
    s_lshl_b32 s5, s5, 4
    s_lshr_b32 s6, s2, 3
    s_add_u32 s5, s5, s6
    s_lshl_b32 s14, s5, 4
    s_lshl_b32 s5, s4, 2
    s_add_u32 s3, s14, s5
    v_and_b32 v1, 63, v0
    s_mul_i32 s5, s3, 896
    v_lshlrev_b32 v2, 4, v1
    v_add_u32 v3, s5, v2
    v_mov_b32 v8, 0
    v_mov_b32 v9, 0
    v_mov_b32 v10, 0
    v_mov_b32 v11, 0
    v_mov_b32 v12, 0
    v_mov_b32 v13, 0
    v_mov_b32 v14, 0
    v_mov_b32 v15, 0
    v_mov_b32 v16, 0
    v_mov_b32 v17, 0
    v_mov_b32 v18, 0
    v_mov_b32 v19, 0
    v_mov_b32 v20, 0
    v_mov_b32 v21, 0
    v_mov_b32 v22, 0
    v_mov_b32 v23, 0
    v_cmp_gt_u32 vcc, 56, v1
    s_mul_i32 s6, s4, 3840
    v_add_u32 v5, s6, v2
    s_waitcnt lgkmcnt(0)
    s_and_saveexec_b64 s[12:13], vcc
    global_load_dwordx4 v[8:11], v3, s[16:17] offset:0
    global_load_dwordx4 v[12:15], v3, s[16:17] offset:896
    global_load_dwordx4 v[16:19], v3, s[16:17] offset:1792
    global_load_dwordx4 v[20:23], v3, s[16:17] offset:2688
    s_mov_b64 exec, s[12:13]
    v_bfe_u32 v6, v1, 4, 1
    v_bfe_u32 v7, v1, 2, 2
    v_lshl_add_u32 v104, v6, 3, v7
    v_mul_u32_u24 v104, 960, v104
    v_and_b32 v105, 3, v1
    s_lshl_b32 s6, s4, 6
    v_lshl_add_u32 v105, v105, 3, s6
    v_lshrrev_b32 v111, 5, v1
    v_lshl_add_u32 v105, v111, 5, v105
    v_add_u32 v106, v104, v105
    v_sub_u32 v104, 7, v7
    v_lshl_add_u32 v104, v6, 3, v104
    v_mul_u32_u24 v104, 960, v104
    v_add_u32 v107, v104, v105
    v_subrev_u32 v110, 3840, v107
    v_and_b32 v104, 15, v1
    v_lshl_add_u32 v104, v111, 4, v104
    s_lshl_b32 s6, s4, 5
    v_add_u32 v104, s6, v104
    v_mul_u32_u24 v108, 4352, v104
    v_lshl_add_u32 v108, v6, 4, v108
    s_lshl_b32 s7, s14, 1
    s_add_u32 s7, s7, 1900544
    v_add_u32 v108, s7, v108
    v_mul_u32_u24 v109, 4160, v104
    v_lshlrev_b32 v105, 4, v6
    v_sub_u32 v109, v109, v105
    s_sub_u32 s7, 2040, s14
    s_lshl_b32 s7, s7, 1
    v_add_u32 v109, s7, v109
    s_waitcnt vmcnt(0)
    s_and_saveexec_b64 s[12:13], vcc
    ds_write_b128 v5, v[8:11] offset:0
    ds_write_b128 v5, v[12:15] offset:960
    ds_write_b128 v5, v[16:19] offset:1920
    ds_write_b128 v5, v[20:23] offset:2880
    s_mov_b64 exec, s[12:13]
    v_lshlrev_b32 v40, 16, v8
    v_and_b32 v41, 0xffff0000, v8
    v_lshlrev_b32 v42, 16, v9
    v_and_b32 v43, 0xffff0000, v9
    v_lshlrev_b32 v44, 16, v10
    v_and_b32 v45, 0xffff0000, v10
    v_lshlrev_b32 v46, 16, v11
    v_and_b32 v47, 0xffff0000, v11
    v_lshlrev_b32 v48, 16, v12
    v_and_b32 v49, 0xffff0000, v12
    v_lshlrev_b32 v50, 16, v13
    v_and_b32 v51, 0xffff0000, v13
    v_lshlrev_b32 v52, 16, v14
    v_and_b32 v53, 0xffff0000, v14
    v_lshlrev_b32 v54, 16, v15
    v_and_b32 v55, 0xffff0000, v15
    v_lshlrev_b32 v56, 16, v16
    v_and_b32 v57, 0xffff0000, v16
    v_lshlrev_b32 v58, 16, v17
    v_and_b32 v59, 0xffff0000, v17
    v_lshlrev_b32 v60, 16, v18
    v_and_b32 v61, 0xffff0000, v18
    v_lshlrev_b32 v62, 16, v19
    v_and_b32 v63, 0xffff0000, v19
    v_lshlrev_b32 v64, 16, v20
    v_and_b32 v65, 0xffff0000, v20
    v_lshlrev_b32 v66, 16, v21
    v_and_b32 v67, 0xffff0000, v21
    v_lshlrev_b32 v68, 16, v22
    v_and_b32 v69, 0xffff0000, v22
    v_lshlrev_b32 v70, 16, v23
    v_and_b32 v71, 0xffff0000, v23
    s_waitcnt lgkmcnt(0)
    s_barrier
    ds_read_b64_tr_b16 v[80:81], v106 offset:0
    ds_read_b64_tr_b16 v[82:83], v106 offset:3840
    ds_read_b64_tr_b16 v[84:85], v106 offset:256
    ds_read_b64_tr_b16 v[86:87], v106 offset:4096
    ds_read_b64_tr_b16 v[88:89], v106 offset:512
    ds_read_b64_tr_b16 v[90:91], v106 offset:4352
    s_cmp_ge_u32 s4, 2
    s_cbranch_scc1 K1_l1_a
    ds_read_b64_tr_b16 v[92:93], v106 offset:768
    ds_read_b64_tr_b16 v[94:95], v106 offset:4608
K1_l1_a:
    s_waitcnt lgkmcnt(0)
    global_store_dwordx4 v108, v[80:83], s[40:41] sc0 sc1
    v_add_u32 v108, 557056, v108
    global_store_dwordx4 v108, v[84:87], s[40:41] sc0 sc1
    v_add_u32 v108, 557056, v108
    global_store_dwordx4 v108, v[88:91], s[40:41] sc0 sc1
    v_add_u32 v108, 557056, v108
    s_cbranch_scc1 K1_l1_b
    global_store_dwordx4 v108, v[92:95], s[40:41] sc0 sc1
K1_l1_b:
    v_add_f32 v120, v40, v41
    v_add_f32 v124, v42, v43
    v_add_f32 v121, v48, v49
    v_add_f32 v125, v50, v51
    v_add_f32 v122, v56, v57
    v_add_f32 v126, v58, v59
    v_add_f32 v123, v64, v65
    v_add_f32 v127, v66, v67
    v_add_f32 v120, v120, v44
    v_add_f32 v124, v124, v45
    v_add_f32 v121, v121, v52
    v_add_f32 v125, v125, v53
    v_add_f32 v122, v122, v60
    v_add_f32 v126, v126, v61
    v_add_f32 v123, v123, v68
    v_add_f32 v127, v127, v69
    v_add_f32 v120, v120, v46
    v_add_f32 v124, v124, v47
    v_add_f32 v121, v121, v54
    v_add_f32 v125, v125, v55
    v_add_f32 v122, v122, v62
    v_add_f32 v126, v126, v63
    v_add_f32 v123, v123, v70
    v_add_f32 v127, v127, v71
    v_add_f32 v120, v120, v124
    v_add_f32 v121, v121, v125
    v_add_f32 v122, v122, v126
    v_add_f32 v123, v123, v127
    v_add_f32_dpp v120, v120, v120 row_shr:1 row_mask:0xf bank_mask:0xf bound_ctrl:0
    v_add_f32_dpp v121, v121, v121 row_shr:1 row_mask:0xf bank_mask:0xf bound_ctrl:0
    v_add_f32_dpp v122, v122, v122 row_shr:1 row_mask:0xf bank_mask:0xf bound_ctrl:0
    v_add_f32_dpp v123, v123, v123 row_shr:1 row_mask:0xf bank_mask:0xf bound_ctrl:0
    v_add_f32_dpp v120, v120, v120 row_shr:2 row_mask:0xf bank_mask:0xf bound_ctrl:0
    v_add_f32_dpp v121, v121, v121 row_shr:2 row_mask:0xf bank_mask:0xf bound_ctrl:0
    v_add_f32_dpp v122, v122, v122 row_shr:2 row_mask:0xf bank_mask:0xf bound_ctrl:0
    v_add_f32_dpp v123, v123, v123 row_shr:2 row_mask:0xf bank_mask:0xf bound_ctrl:0
    v_add_f32_dpp v120, v120, v120 row_shr:4 row_mask:0xf bank_mask:0xf bound_ctrl:0
    v_add_f32_dpp v121, v121, v121 row_shr:4 row_mask:0xf bank_mask:0xf bound_ctrl:0
    v_add_f32_dpp v122, v122, v122 row_shr:4 row_mask:0xf bank_mask:0xf bound_ctrl:0
    v_add_f32_dpp v123, v123, v123 row_shr:4 row_mask:0xf bank_mask:0xf bound_ctrl:0
    v_add_f32_dpp v120, v120, v120 row_shr:8 row_mask:0xf bank_mask:0xf bound_ctrl:0
    v_add_f32_dpp v121, v121, v121 row_shr:8 row_mask:0xf bank_mask:0xf bound_ctrl:0
    v_add_f32_dpp v122, v122, v122 row_shr:8 row_mask:0xf bank_mask:0xf bound_ctrl:0
    v_add_f32_dpp v123, v123, v123 row_shr:8 row_mask:0xf bank_mask:0xf bound_ctrl:0
    v_add_f32_dpp v120, v120, v120 row_bcast:15 row_mask:0xa bank_mask:0xf
    v_add_f32_dpp v121, v121, v121 row_bcast:15 row_mask:0xa bank_mask:0xf
    v_add_f32_dpp v122, v122, v122 row_bcast:15 row_mask:0xa bank_mask:0xf
    v_add_f32_dpp v123, v123, v123 row_bcast:15 row_mask:0xa bank_mask:0xf
    v_add_f32_dpp v120, v120, v120 row_bcast:31 row_mask:0xc bank_mask:0xf
    v_add_f32_dpp v121, v121, v121 row_bcast:31 row_mask:0xc bank_mask:0xf
    v_add_f32_dpp v122, v122, v122 row_bcast:31 row_mask:0xc bank_mask:0xf
    v_add_f32_dpp v123, v123, v123 row_bcast:31 row_mask:0xc bank_mask:0xf
    v_readlane_b32 s44, v120, 63
    v_readlane_b32 s45, v121, 63
    v_readlane_b32 s46, v122, 63
    v_readlane_b32 s47, v123, 63
    v_mov_b32 v111, 0x3b124925
    v_mul_f32 v112, s44, v111
    v_mul_f32 v113, s45, v111
    v_mul_f32 v114, s46, v111
    v_mul_f32 v115, s47, v111
    v_mov_b32 v120, 0
    v_mov_b32 v121, 0
    v_mov_b32 v122, 0
    v_mov_b32 v123, 0
    v_mov_b32 v124, 0
    v_mov_b32 v125, 0
    v_mov_b32 v126, 0
    v_mov_b32 v127, 0
    s_and_saveexec_b64 s[12:13], vcc
    v_sub_f32 v24, v40, v112
    v_sub_f32 v28, v41, v112
    v_sub_f32 v25, v48, v113
    v_sub_f32 v29, v49, v113
    v_sub_f32 v26, v56, v114
    v_sub_f32 v30, v57, v114
    v_sub_f32 v27, v64, v115
    v_sub_f32 v31, v65, v115
    v_fmac_f32 v120, v24, v24
    v_fmac_f32 v124, v28, v28
    v_fmac_f32 v121, v25, v25
    v_fmac_f32 v125, v29, v29
    v_fmac_f32 v122, v26, v26
    v_fmac_f32 v126, v30, v30
    v_fmac_f32 v123, v27, v27
    v_fmac_f32 v127, v31, v31
    v_sub_f32 v24, v42, v112
    v_sub_f32 v28, v43, v112
    v_sub_f32 v25, v50, v113
    v_sub_f32 v29, v51, v113
    v_sub_f32 v26, v58, v114
    v_sub_f32 v30, v59, v114
    v_sub_f32 v27, v66, v115
    v_sub_f32 v31, v67, v115
    v_fmac_f32 v120, v24, v24
    v_fmac_f32 v124, v28, v28
    v_fmac_f32 v121, v25, v25
    v_fmac_f32 v125, v29, v29
    v_fmac_f32 v122, v26, v26
    v_fmac_f32 v126, v30, v30
    v_fmac_f32 v123, v27, v27
    v_fmac_f32 v127, v31, v31
    v_sub_f32 v24, v44, v112
    v_sub_f32 v28, v45, v112
    v_sub_f32 v25, v52, v113
    v_sub_f32 v29, v53, v113
    v_sub_f32 v26, v60, v114
    v_sub_f32 v30, v61, v114
    v_sub_f32 v27, v68, v115
    v_sub_f32 v31, v69, v115
    v_fmac_f32 v120, v24, v24
    v_fmac_f32 v124, v28, v28
    v_fmac_f32 v121, v25, v25
    v_fmac_f32 v125, v29, v29
    v_fmac_f32 v122, v26, v26
    v_fmac_f32 v126, v30, v30
    v_fmac_f32 v123, v27, v27
    v_fmac_f32 v127, v31, v31
    v_sub_f32 v24, v46, v112
    v_sub_f32 v28, v47, v112
    v_sub_f32 v25, v54, v113
    v_sub_f32 v29, v55, v113
    v_sub_f32 v26, v62, v114
    v_sub_f32 v30, v63, v114
    v_sub_f32 v27, v70, v115
    v_sub_f32 v31, v71, v115
    v_fmac_f32 v120, v24, v24
    v_fmac_f32 v124, v28, v28
    v_fmac_f32 v121, v25, v25
    v_fmac_f32 v125, v29, v29
    v_fmac_f32 v122, v26, v26
    v_fmac_f32 v126, v30, v30
    v_fmac_f32 v123, v27, v27
    v_fmac_f32 v127, v31, v31
    s_mov_b64 exec, s[12:13]
    v_add_f32 v120, v120, v124
    v_add_f32 v121, v121, v125
    v_add_f32 v122, v122, v126
    v_add_f32 v123, v123, v127
    v_add_f32_dpp v120, v120, v120 row_shr:1 row_mask:0xf bank_mask:0xf bound_ctrl:0
    v_add_f32_dpp v121, v121, v121 row_shr:1 row_mask:0xf bank_mask:0xf bound_ctrl:0
    v_add_f32_dpp v122, v122, v122 row_shr:1 row_mask:0xf bank_mask:0xf bound_ctrl:0
    v_add_f32_dpp v123, v123, v123 row_shr:1 row_mask:0xf bank_mask:0xf bound_ctrl:0
    v_add_f32_dpp v120, v120, v120 row_shr:2 row_mask:0xf bank_mask:0xf bound_ctrl:0
    v_add_f32_dpp v121, v121, v121 row_shr:2 row_mask:0xf bank_mask:0xf bound_ctrl:0
    v_add_f32_dpp v122, v122, v122 row_shr:2 row_mask:0xf bank_mask:0xf bound_ctrl:0
    v_add_f32_dpp v123, v123, v123 row_shr:2 row_mask:0xf bank_mask:0xf bound_ctrl:0
    v_add_f32_dpp v120, v120, v120 row_shr:4 row_mask:0xf bank_mask:0xf bound_ctrl:0
    v_add_f32_dpp v121, v121, v121 row_shr:4 row_mask:0xf bank_mask:0xf bound_ctrl:0
    v_add_f32_dpp v122, v122, v122 row_shr:4 row_mask:0xf bank_mask:0xf bound_ctrl:0
    v_add_f32_dpp v123, v123, v123 row_shr:4 row_mask:0xf bank_mask:0xf bound_ctrl:0
    v_add_f32_dpp v120, v120, v120 row_shr:8 row_mask:0xf bank_mask:0xf bound_ctrl:0
    v_add_f32_dpp v121, v121, v121 row_shr:8 row_mask:0xf bank_mask:0xf bound_ctrl:0
    v_add_f32_dpp v122, v122, v122 row_shr:8 row_mask:0xf bank_mask:0xf bound_ctrl:0
    v_add_f32_dpp v123, v123, v123 row_shr:8 row_mask:0xf bank_mask:0xf bound_ctrl:0
    v_add_f32_dpp v120, v120, v120 row_bcast:15 row_mask:0xa bank_mask:0xf
    v_add_f32_dpp v121, v121, v121 row_bcast:15 row_mask:0xa bank_mask:0xf
    v_add_f32_dpp v122, v122, v122 row_bcast:15 row_mask:0xa bank_mask:0xf
    v_add_f32_dpp v123, v123, v123 row_bcast:15 row_mask:0xa bank_mask:0xf
    v_add_f32_dpp v120, v120, v120 row_bcast:31 row_mask:0xc bank_mask:0xf
    v_add_f32_dpp v121, v121, v121 row_bcast:31 row_mask:0xc bank_mask:0xf
    v_add_f32_dpp v122, v122, v122 row_bcast:31 row_mask:0xc bank_mask:0xf
    v_add_f32_dpp v123, v123, v123 row_bcast:31 row_mask:0xc bank_mask:0xf
    v_readlane_b32 s44, v120, 63
    v_readlane_b32 s45, v121, 63
    v_readlane_b32 s46, v122, 63
    v_readlane_b32 s47, v123, 63
    v_mul_f32 v120, s44, v111
    v_mul_f32 v121, s45, v111
    v_mul_f32 v122, s46, v111
    v_mul_f32 v123, s47, v111
    v_cvt_pk_bf16_f32 v120, v120, v112
    v_cvt_pk_bf16_f32 v121, v121, v113
    v_cvt_pk_bf16_f32 v122, v122, v114
    v_cvt_pk_bf16_f32 v123, v123, v115
    v_and_b32 v112, 0xffff0000, v120
    v_lshlrev_b32 v120, 16, v120
    v_and_b32 v113, 0xffff0000, v121
    v_lshlrev_b32 v121, 16, v121
    v_and_b32 v114, 0xffff0000, v122
    v_lshlrev_b32 v122, 16, v122
    v_and_b32 v115, 0xffff0000, v123
    v_lshlrev_b32 v123, 16, v123
    v_add_f32 v120, 0x3727c5ac, v120
    v_add_f32 v121, 0x3727c5ac, v121
    v_add_f32 v122, 0x3727c5ac, v122
    v_add_f32 v123, 0x3727c5ac, v123
    v_cvt_pk_bf16_f32 v120, v120, v120
    v_cvt_pk_bf16_f32 v121, v121, v121
    v_cvt_pk_bf16_f32 v122, v122, v122
    v_cvt_pk_bf16_f32 v123, v123, v123
    v_lshlrev_b32 v120, 16, v120
    v_lshlrev_b32 v121, 16, v121
    v_lshlrev_b32 v122, 16, v122
    v_lshlrev_b32 v123, 16, v123
    v_sqrt_f32 v120, v120
    v_sqrt_f32 v121, v121
    v_sqrt_f32 v122, v122
    v_sqrt_f32 v123, v123
    v_cvt_pk_bf16_f32 v120, v120, v120
    v_cvt_pk_bf16_f32 v121, v121, v121
    v_cvt_pk_bf16_f32 v122, v122, v122
    v_cvt_pk_bf16_f32 v123, v123, v123
    v_lshlrev_b32 v120, 16, v120
    v_lshlrev_b32 v121, 16, v121
    v_lshlrev_b32 v122, 16, v122
    v_lshlrev_b32 v123, 16, v123
    v_rcp_f32 v124, v120
    v_rcp_f32 v125, v121
    v_rcp_f32 v126, v122
    v_rcp_f32 v127, v123
    v_sub_f32 v40, v40, v112
    v_sub_f32 v41, v41, v112
    v_sub_f32 v42, v42, v112
    v_sub_f32 v43, v43, v112
    v_sub_f32 v44, v44, v112
    v_sub_f32 v45, v45, v112
    v_sub_f32 v46, v46, v112
    v_sub_f32 v47, v47, v112
    v_sub_f32 v48, v48, v113
    v_sub_f32 v49, v49, v113
    v_sub_f32 v50, v50, v113
    v_sub_f32 v51, v51, v113
    v_sub_f32 v52, v52, v113
    v_sub_f32 v53, v53, v113
    v_sub_f32 v54, v54, v113
    v_sub_f32 v55, v55, v113
    v_sub_f32 v56, v56, v114
    v_sub_f32 v57, v57, v114
    v_sub_f32 v58, v58, v114
    v_sub_f32 v59, v59, v114
    v_sub_f32 v60, v60, v114
    v_sub_f32 v61, v61, v114
    v_sub_f32 v62, v62, v114
    v_sub_f32 v63, v63, v114
    v_sub_f32 v64, v64, v115
    v_sub_f32 v65, v65, v115
    v_sub_f32 v66, v66, v115
    v_sub_f32 v67, v67, v115
    v_sub_f32 v68, v68, v115
    v_sub_f32 v69, v69, v115
    v_sub_f32 v70, v70, v115
    v_sub_f32 v71, v71, v115
    v_cvt_pk_bf16_f32 v8, v40, v41
    v_cvt_pk_bf16_f32 v9, v42, v43
    v_cvt_pk_bf16_f32 v10, v44, v45
    v_cvt_pk_bf16_f32 v11, v46, v47
    v_cvt_pk_bf16_f32 v16, v48, v49
    v_cvt_pk_bf16_f32 v17, v50, v51
    v_cvt_pk_bf16_f32 v18, v52, v53
    v_cvt_pk_bf16_f32 v19, v54, v55
    v_cvt_pk_bf16_f32 v24, v56, v57
    v_cvt_pk_bf16_f32 v25, v58, v59
    v_cvt_pk_bf16_f32 v26, v60, v61
    v_cvt_pk_bf16_f32 v27, v62, v63
    v_cvt_pk_bf16_f32 v32, v64, v65
    v_cvt_pk_bf16_f32 v33, v66, v67
    v_cvt_pk_bf16_f32 v34, v68, v69
    v_cvt_pk_bf16_f32 v35, v70, v71
    v_lshlrev_b32 v40, 16, v8
    v_and_b32 v41, 0xffff0000, v8
    v_lshlrev_b32 v42, 16, v9
    v_and_b32 v43, 0xffff0000, v9
    v_lshlrev_b32 v44, 16, v10
    v_and_b32 v45, 0xffff0000, v10
    v_lshlrev_b32 v46, 16, v11
    v_and_b32 v47, 0xffff0000, v11
    v_lshlrev_b32 v48, 16, v16
    v_and_b32 v49, 0xffff0000, v16
    v_lshlrev_b32 v50, 16, v17
    v_and_b32 v51, 0xffff0000, v17
    v_lshlrev_b32 v52, 16, v18
    v_and_b32 v53, 0xffff0000, v18
    v_lshlrev_b32 v54, 16, v19
    v_and_b32 v55, 0xffff0000, v19
    v_lshlrev_b32 v56, 16, v24
    v_and_b32 v57, 0xffff0000, v24
    v_lshlrev_b32 v58, 16, v25
    v_and_b32 v59, 0xffff0000, v25
    v_lshlrev_b32 v60, 16, v26
    v_and_b32 v61, 0xffff0000, v26
    v_lshlrev_b32 v62, 16, v27
    v_and_b32 v63, 0xffff0000, v27
    v_lshlrev_b32 v64, 16, v32
    v_and_b32 v65, 0xffff0000, v32
    v_lshlrev_b32 v66, 16, v33
    v_and_b32 v67, 0xffff0000, v33
    v_lshlrev_b32 v68, 16, v34
    v_and_b32 v69, 0xffff0000, v34
    v_lshlrev_b32 v70, 16, v35
    v_and_b32 v71, 0xffff0000, v35
    v_mul_f32 v8, v124, v40
    v_mul_f32 v9, v124, v41
    v_mul_f32 v10, v124, v42
    v_mul_f32 v11, v124, v43
    v_mul_f32 v12, v124, v44
    v_mul_f32 v13, v124, v45
    v_mul_f32 v14, v124, v46
    v_mul_f32 v15, v124, v47
    v_mul_f32 v16, v125, v48
    v_mul_f32 v17, v125, v49
    v_mul_f32 v18, v125, v50
    v_mul_f32 v19, v125, v51
    v_mul_f32 v20, v125, v52
    v_mul_f32 v21, v125, v53
    v_mul_f32 v22, v125, v54
    v_mul_f32 v23, v125, v55
    v_mul_f32 v24, v126, v56
    v_mul_f32 v25, v126, v57
    v_mul_f32 v26, v126, v58
    v_mul_f32 v27, v126, v59
    v_mul_f32 v28, v126, v60
    v_mul_f32 v29, v126, v61
    v_mul_f32 v30, v126, v62
    v_mul_f32 v31, v126, v63
    v_mul_f32 v32, v127, v64
    v_mul_f32 v33, v127, v65
    v_mul_f32 v34, v127, v66
    v_mul_f32 v35, v127, v67
    v_mul_f32 v36, v127, v68
    v_mul_f32 v37, v127, v69
    v_mul_f32 v38, v127, v70
    v_mul_f32 v39, v127, v71
    v_fma_f32 v40, -v8, v120, v40
    v_fma_f32 v41, -v9, v120, v41
    v_fma_f32 v42, -v10, v120, v42
    v_fma_f32 v43, -v11, v120, v43
    v_fma_f32 v44, -v12, v120, v44
    v_fma_f32 v45, -v13, v120, v45
    v_fma_f32 v46, -v14, v120, v46
    v_fma_f32 v47, -v15, v120, v47
    v_fma_f32 v48, -v16, v121, v48
    v_fma_f32 v49, -v17, v121, v49
    v_fma_f32 v50, -v18, v121, v50
    v_fma_f32 v51, -v19, v121, v51
    v_fma_f32 v52, -v20, v121, v52
    v_fma_f32 v53, -v21, v121, v53
    v_fma_f32 v54, -v22, v121, v54
    v_fma_f32 v55, -v23, v121, v55
    v_fma_f32 v56, -v24, v122, v56
    v_fma_f32 v57, -v25, v122, v57
    v_fma_f32 v58, -v26, v122, v58
    v_fma_f32 v59, -v27, v122, v59
    v_fma_f32 v60, -v28, v122, v60
    v_fma_f32 v61, -v29, v122, v61
    v_fma_f32 v62, -v30, v122, v62
    v_fma_f32 v63, -v31, v122, v63
    v_fma_f32 v64, -v32, v123, v64
    v_fma_f32 v65, -v33, v123, v65
    v_fma_f32 v66, -v34, v123, v66
    v_fma_f32 v67, -v35, v123, v67
    v_fma_f32 v68, -v36, v123, v68
    v_fma_f32 v69, -v37, v123, v69
    v_fma_f32 v70, -v38, v123, v70
    v_fma_f32 v71, -v39, v123, v71
    v_fma_f32 v40, v40, v124, v8
    v_fma_f32 v41, v41, v124, v9
    v_fma_f32 v42, v42, v124, v10
    v_fma_f32 v43, v43, v124, v11
    v_fma_f32 v44, v44, v124, v12
    v_fma_f32 v45, v45, v124, v13
    v_fma_f32 v46, v46, v124, v14
    v_fma_f32 v47, v47, v124, v15
    v_fma_f32 v48, v48, v125, v16
    v_fma_f32 v49, v49, v125, v17
    v_fma_f32 v50, v50, v125, v18
    v_fma_f32 v51, v51, v125, v19
    v_fma_f32 v52, v52, v125, v20
    v_fma_f32 v53, v53, v125, v21
    v_fma_f32 v54, v54, v125, v22
    v_fma_f32 v55, v55, v125, v23
    v_fma_f32 v56, v56, v126, v24
    v_fma_f32 v57, v57, v126, v25
    v_fma_f32 v58, v58, v126, v26
    v_fma_f32 v59, v59, v126, v27
    v_fma_f32 v60, v60, v126, v28
    v_fma_f32 v61, v61, v126, v29
    v_fma_f32 v62, v62, v126, v30
    v_fma_f32 v63, v63, v126, v31
    v_fma_f32 v64, v64, v127, v32
    v_fma_f32 v65, v65, v127, v33
    v_fma_f32 v66, v66, v127, v34
    v_fma_f32 v67, v67, v127, v35
    v_fma_f32 v68, v68, v127, v36
    v_fma_f32 v69, v69, v127, v37
    v_fma_f32 v70, v70, v127, v38
    v_fma_f32 v71, v71, v127, v39
    v_cvt_pk_bf16_f32 v8, v40, v41
    v_cvt_pk_bf16_f32 v9, v42, v43
    v_cvt_pk_bf16_f32 v10, v44, v45
    v_cvt_pk_bf16_f32 v11, v46, v47
    v_cvt_pk_bf16_f32 v16, v48, v49
    v_cvt_pk_bf16_f32 v17, v50, v51
    v_cvt_pk_bf16_f32 v18, v52, v53
    v_cvt_pk_bf16_f32 v19, v54, v55
    v_cvt_pk_bf16_f32 v24, v56, v57
    v_cvt_pk_bf16_f32 v25, v58, v59
    v_cvt_pk_bf16_f32 v26, v60, v61
    v_cvt_pk_bf16_f32 v27, v62, v63
    v_cvt_pk_bf16_f32 v32, v64, v65
    v_cvt_pk_bf16_f32 v33, v66, v67
    v_cvt_pk_bf16_f32 v34, v68, v69
    v_cvt_pk_bf16_f32 v35, v70, v71
    v_lshlrev_b32 v40, 16, v8
    v_and_b32 v41, 0xffff0000, v8
    v_lshlrev_b32 v42, 16, v9
    v_and_b32 v43, 0xffff0000, v9
    v_lshlrev_b32 v44, 16, v10
    v_and_b32 v45, 0xffff0000, v10
    v_lshlrev_b32 v46, 16, v11
    v_and_b32 v47, 0xffff0000, v11
    v_lshlrev_b32 v48, 16, v16
    v_and_b32 v49, 0xffff0000, v16
    v_lshlrev_b32 v50, 16, v17
    v_and_b32 v51, 0xffff0000, v17
    v_lshlrev_b32 v52, 16, v18
    v_and_b32 v53, 0xffff0000, v18
    v_lshlrev_b32 v54, 16, v19
    v_and_b32 v55, 0xffff0000, v19
    v_lshlrev_b32 v56, 16, v24
    v_and_b32 v57, 0xffff0000, v24
    v_lshlrev_b32 v58, 16, v25
    v_and_b32 v59, 0xffff0000, v25
    v_lshlrev_b32 v60, 16, v26
    v_and_b32 v61, 0xffff0000, v26
    v_lshlrev_b32 v62, 16, v27
    v_and_b32 v63, 0xffff0000, v27
    v_lshlrev_b32 v64, 16, v32
    v_and_b32 v65, 0xffff0000, v32
    v_lshlrev_b32 v66, 16, v33
    v_and_b32 v67, 0xffff0000, v33
    v_lshlrev_b32 v68, 16, v34
    v_and_b32 v69, 0xffff0000, v34
    v_lshlrev_b32 v70, 16, v35
    v_and_b32 v71, 0xffff0000, v35
    v_cvt_pkrtz_f16_f32 v8, v40, v41
    v_cvt_pkrtz_f16_f32 v9, v42, v43
    v_cvt_pkrtz_f16_f32 v10, v44, v45
    v_cvt_pkrtz_f16_f32 v11, v46, v47
    v_cvt_pkrtz_f16_f32 v16, v48, v49
    v_cvt_pkrtz_f16_f32 v17, v50, v51
    v_cvt_pkrtz_f16_f32 v18, v52, v53
    v_cvt_pkrtz_f16_f32 v19, v54, v55
    v_cvt_pkrtz_f16_f32 v24, v56, v57
    v_cvt_pkrtz_f16_f32 v25, v58, v59
    v_cvt_pkrtz_f16_f32 v26, v60, v61
    v_cvt_pkrtz_f16_f32 v27, v62, v63
    v_cvt_pkrtz_f16_f32 v32, v64, v65
    v_cvt_pkrtz_f16_f32 v33, v66, v67
    v_cvt_pkrtz_f16_f32 v34, v68, v69
    v_cvt_pkrtz_f16_f32 v35, v70, v71
    s_barrier
    s_and_saveexec_b64 s[12:13], vcc
    ds_write_b128 v5, v[8:11] offset:0
    ds_write_b128 v5, v[16:19] offset:960
    ds_write_b128 v5, v[24:27] offset:1920
    ds_write_b128 v5, v[32:35] offset:2880
    s_mov_b64 exec, s[12:13]
    s_waitcnt vmcnt(0) lgkmcnt(0)
    s_barrier
    ds_read_b64_tr_b16 v[80:81], v107 offset:0
    ds_read_b64_tr_b16 v[82:83], v110 offset:0
    ds_read_b64_tr_b16 v[84:85], v107 offset:256
    ds_read_b64_tr_b16 v[86:87], v110 offset:256
    ds_read_b64_tr_b16 v[88:89], v107 offset:512
    ds_read_b64_tr_b16 v[90:91], v110 offset:512
    s_cmp_ge_u32 s4, 2
    s_cbranch_scc1 K1_l2_a
    ds_read_b64_tr_b16 v[92:93], v107 offset:768
    ds_read_b64_tr_b16 v[94:95], v110 offset:768
K1_l2_a:
    s_waitcnt lgkmcnt(0)
    global_store_dwordx4 v109, v[80:83], s[40:41] sc0 sc1
    v_add_u32 v109, 532480, v109
    global_store_dwordx4 v109, v[84:87], s[40:41] sc0 sc1
    v_add_u32 v109, 532480, v109
    global_store_dwordx4 v109, v[88:91], s[40:41] sc0 sc1
    v_add_u32 v109, 532480, v109
    s_cbranch_scc1 K1_l2_b
    global_store_dwordx4 v109, v[92:95], s[40:41] sc0 sc1
K1_l2_b:
    s_endpgm
K1_wp:
    s_sub_u32 s15, s2, 576
    v_lshrrev_b32 v1, 6, v0
    s_sub_u32 s3, s2, 576
    v_readfirstlane_b32 s4, v1
    v_and_b32 v1, 63, v0
    s_lshl_b32 s3, s3, 3
    s_lshl_b32 s5, s4, 1
    s_add_u32 s3, s3, s5
    s_mul_i32 s6, s4, 6144
    v_lshrrev_b32 v2, 3, v1
    v_and_b32 v3, 7, v1
    v_mul_u32_u24 v4, 192, v2
    v_lshl_add_u32 v4, v3, 4, v4
    v_add_u32 v4, s6, v4
    v_lshrrev_b32 v5, 5, v1
    v_bfe_u32 v6, v1, 2, 2
    v_lshl_add_u32 v5, v5, 2, v6
    v_mul_u32_u24 v5, 192, v5
    v_bfe_u32 v6, v1, 4, 1
    v_lshl_add_u32 v5, v6, 5, v5
    v_and_b32 v6, 3, v1
    v_lshl_add_u32 v5, v6, 3, v5
    v_add_u32 v5, s6, v5
    v_lshlrev_b32 v7, 4, v1
    s_waitcnt lgkmcnt(0)
    s_cmp_lt_u32 s3, 784
    s_cbranch_scc0 K1_wp_w2
    v_mul_u32_u24 v8, 3584, v2
    v_lshl_add_u32 v8, v3, 4, v8
    s_add_u32 s7, s3, 0
    s_mul_i32 s8, s7, 2341
    s_lshr_b32 s8, s8, 16
    s_mul_i32 s9, s8, 28
    s_sub_u32 s9, s7, s9
    s_mul_i32 s10, s8, 57344
    s_lshl_b32 s11, s9, 7
    s_add_u32 s10, s10, s11
    v_add_u32 v9, s10, v8
    v_add_u32 v10, 28672, v9
    global_load_dwordx4 v[16:19], v9, s[32:33]
    global_load_dwordx4 v[20:23], v10, s[32:33]
    s_mul_i32 s10, s9, 56
    s_add_u32 s10, s10, s8
    s_lshl_b32 s10, s10, 10
    s_add_u32 s10, s10, 9175040
    v_add_u32 v11, s10, v7
    v_add_u32 v12, 28672, v11
    s_add_u32 s7, s3, 1
    s_mul_i32 s8, s7, 2341
    s_lshr_b32 s8, s8, 16
    s_mul_i32 s9, s8, 28
    s_sub_u32 s9, s7, s9
    s_mul_i32 s10, s8, 57344
    s_lshl_b32 s11, s9, 7
    s_add_u32 s10, s10, s11
    v_add_u32 v9, s10, v8
    v_add_u32 v10, 28672, v9
    global_load_dwordx4 v[24:27], v9, s[32:33]
    global_load_dwordx4 v[28:31], v10, s[32:33]
    s_mul_i32 s10, s9, 56
    s_add_u32 s10, s10, s8
    s_lshl_b32 s10, s10, 10
    s_add_u32 s10, s10, 9175040
    v_add_u32 v13, s10, v7
    v_add_u32 v14, 28672, v13
    s_waitcnt vmcnt(2)
    ds_write_b128 v4, v[16:19] offset:0
    ds_write_b128 v4, v[20:23] offset:1536
    s_waitcnt vmcnt(0)
    ds_write_b128 v4, v[24:27] offset:3072
    ds_write_b128 v4, v[28:31] offset:4608
    ds_read_b64_tr_b16 v[32:33], v5 offset:0
    ds_read_b64_tr_b16 v[34:35], v5 offset:1536
    ds_read_b64_tr_b16 v[36:37], v5 offset:64
    ds_read_b64_tr_b16 v[38:39], v5 offset:1600
    ds_read_b64_tr_b16 v[40:41], v5 offset:3072
    ds_read_b64_tr_b16 v[42:43], v5 offset:4608
    ds_read_b64_tr_b16 v[44:45], v5 offset:3136
    ds_read_b64_tr_b16 v[46:47], v5 offset:4672
    s_waitcnt lgkmcnt(6)
    global_store_dwordx4 v11, v[32:35], s[40:41] sc0 sc1
    s_waitcnt lgkmcnt(4)
    global_store_dwordx4 v12, v[36:39], s[40:41] sc0 sc1
    s_waitcnt lgkmcnt(2)
    global_store_dwordx4 v13, v[40:43], s[40:41] sc0 sc1
    s_waitcnt lgkmcnt(0)
    global_store_dwordx4 v14, v[44:47], s[40:41] sc0 sc1
    s_endpgm
K1_wp_w2:
    s_sub_u32 s3, s3, 784
    v_mul_u32_u24 v8, 896, v2
    v_lshl_add_u32 v8, v3, 4, v8
    s_add_u32 s7, s3, 0
    s_mul_i32 s8, s7, 9363
    s_lshr_b32 s8, s8, 16
    s_mul_i32 s9, s8, 7
    s_sub_u32 s9, s7, s9
    s_mul_i32 s10, s8, 14336
    s_lshl_b32 s11, s9, 7
    s_add_u32 s10, s10, s11
    v_add_u32 v9, s10, v8
    v_add_u32 v10, 7168, v9
    global_load_dwordx4 v[16:19], v9, s[36:37]
    global_load_dwordx4 v[20:23], v10, s[36:37]
    s_mul_i32 s10, s9, 224
    s_add_u32 s10, s10, s8
    s_lshl_b32 s10, s10, 10
    s_add_u32 s10, s10, 10813440
    v_add_u32 v11, s10, v7
    v_add_u32 v12, 114688, v11
    s_add_u32 s7, s3, 1
    s_mul_i32 s8, s7, 9363
    s_lshr_b32 s8, s8, 16
    s_mul_i32 s9, s8, 7
    s_sub_u32 s9, s7, s9
    s_mul_i32 s10, s8, 14336
    s_lshl_b32 s11, s9, 7
    s_add_u32 s10, s10, s11
    v_add_u32 v9, s10, v8
    v_add_u32 v10, 7168, v9
    global_load_dwordx4 v[24:27], v9, s[36:37]
    global_load_dwordx4 v[28:31], v10, s[36:37]
    s_mul_i32 s10, s9, 224
    s_add_u32 s10, s10, s8
    s_lshl_b32 s10, s10, 10
    s_add_u32 s10, s10, 10813440
    v_add_u32 v13, s10, v7
    v_add_u32 v14, 114688, v13
    s_waitcnt vmcnt(2)
    ds_write_b128 v4, v[16:19] offset:0
    ds_write_b128 v4, v[20:23] offset:1536
    s_waitcnt vmcnt(0)
    ds_write_b128 v4, v[24:27] offset:3072
    ds_write_b128 v4, v[28:31] offset:4608
    ds_read_b64_tr_b16 v[32:33], v5 offset:0
    ds_read_b64_tr_b16 v[34:35], v5 offset:1536
    ds_read_b64_tr_b16 v[36:37], v5 offset:64
    ds_read_b64_tr_b16 v[38:39], v5 offset:1600
    ds_read_b64_tr_b16 v[40:41], v5 offset:3072
    ds_read_b64_tr_b16 v[42:43], v5 offset:4608
    ds_read_b64_tr_b16 v[44:45], v5 offset:3136
    ds_read_b64_tr_b16 v[46:47], v5 offset:4672
    s_waitcnt lgkmcnt(6)
    global_store_dwordx4 v11, v[32:35], s[40:41] sc0 sc1
    s_waitcnt lgkmcnt(4)
    global_store_dwordx4 v12, v[36:39], s[40:41] sc0 sc1
    s_waitcnt lgkmcnt(2)
    global_store_dwordx4 v13, v[40:43], s[40:41] sc0 sc1
    s_waitcnt lgkmcnt(0)
    global_store_dwordx4 v14, v[44:47], s[40:41] sc0 sc1
    s_endpgm
K1_cs:
    s_sub_u32 s3, s2, 772
    s_lshl_b32 s4, s3, 7
    v_lshrrev_b32 v1, 3, v0
    v_and_b32 v2, 7, v0
    v_mul_u32_u24 v3, 50176, v1
    v_lshl_add_u32 v3, v2, 4, v3
    v_add_u32 v3, s4, v3
    v_lshlrev_b32 v4, 8, v1
    v_lshl_add_u32 v4, v2, 5, v4
    v_lshlrev_b32 v5, 2, v0
    v_and_b32 v6, 63, v0
    v_lshl_add_u32 v6, v6, 1, s4
    s_waitcnt lgkmcnt(0)
    global_load_ushort v7, v6, s[34:35]
    s_lshl_b32 s5, s3, 13
    s_add_u32 s5, s5, 21823488
    v_lshl_add_u32 v6, v0, 4, s5
    v_mov_b32 v8, 0
    v_mov_b32 v9, 0
    v_mov_b32 v10, 0
    v_mov_b32 v11, 0
    global_store_dwordx4 v6, v[8:11], s[40:41] sc0 sc1
    v_add_u32 v6, 4096, v6
    global_store_dwordx4 v6, v[8:11], s[40:41] sc0 sc1
    global_load_dwordx4 v[16:19], v3, s[32:33]
    v_add_u32 v3, 3584, v3
    global_load_dwordx4 v[20:23], v3, s[32:33]
    v_add_u32 v3, 3584, v3
    global_load_dwordx4 v[24:27], v3, s[32:33]
    v_add_u32 v3, 3584, v3
    global_load_dwordx4 v[28:31], v3, s[32:33]
    v_add_u32 v3, 3584, v3
    global_load_dwordx4 v[32:35], v3, s[32:33]
    v_add_u32 v3, 3584, v3
    global_load_dwordx4 v[36:39], v3, s[32:33]
    v_add_u32 v3, 3584, v3
    global_load_dwordx4 v[40:43], v3, s[32:33]
    v_add_u32 v3, 3584, v3
    global_load_dwordx4 v[44:47], v3, s[32:33]
    v_add_u32 v3, 3584, v3
    global_load_dwordx4 v[48:51], v3, s[32:33]
    v_add_u32 v3, 3584, v3
    global_load_dwordx4 v[52:55], v3, s[32:33]
    v_add_u32 v3, 3584, v3
    global_load_dwordx4 v[56:59], v3, s[32:33]
    v_add_u32 v3, 3584, v3
    global_load_dwordx4 v[60:63], v3, s[32:33]
    v_add_u32 v3, 3584, v3
    global_load_dwordx4 v[64:67], v3, s[32:33]
    v_add_u32 v3, 3584, v3
    global_load_dwordx4 v[68:71], v3, s[32:33]
    v_mov_b32 v8, 0
    v_mov_b32 v9, 0
    v_mov_b32 v10, 0
    v_mov_b32 v11, 0
    v_mov_b32 v12, 0
    v_mov_b32 v13, 0
    v_mov_b32 v14, 0
    v_mov_b32 v15, 0
    s_waitcnt vmcnt(13)
    v_lshlrev_b32 v80, 16, v16
    v_and_b32 v81, 0xffff0000, v16
    v_lshlrev_b32 v82, 16, v17
    v_and_b32 v83, 0xffff0000, v17
    v_lshlrev_b32 v84, 16, v18
    v_and_b32 v85, 0xffff0000, v18
    v_lshlrev_b32 v86, 16, v19
    v_and_b32 v87, 0xffff0000, v19
    v_add_f32 v8, v8, v80
    v_add_f32 v9, v9, v81
    v_add_f32 v10, v10, v82
    v_add_f32 v11, v11, v83
    v_add_f32 v12, v12, v84
    v_add_f32 v13, v13, v85
    v_add_f32 v14, v14, v86
    v_add_f32 v15, v15, v87
    s_waitcnt vmcnt(12)
    v_lshlrev_b32 v80, 16, v20
    v_and_b32 v81, 0xffff0000, v20
    v_lshlrev_b32 v82, 16, v21
    v_and_b32 v83, 0xffff0000, v21
    v_lshlrev_b32 v84, 16, v22
    v_and_b32 v85, 0xffff0000, v22
    v_lshlrev_b32 v86, 16, v23
    v_and_b32 v87, 0xffff0000, v23
    v_add_f32 v8, v8, v80
    v_add_f32 v9, v9, v81
    v_add_f32 v10, v10, v82
    v_add_f32 v11, v11, v83
    v_add_f32 v12, v12, v84
    v_add_f32 v13, v13, v85
    v_add_f32 v14, v14, v86
    v_add_f32 v15, v15, v87
    s_waitcnt vmcnt(11)
    v_lshlrev_b32 v80, 16, v24
    v_and_b32 v81, 0xffff0000, v24
    v_lshlrev_b32 v82, 16, v25
    v_and_b32 v83, 0xffff0000, v25
    v_lshlrev_b32 v84, 16, v26
    v_and_b32 v85, 0xffff0000, v26
    v_lshlrev_b32 v86, 16, v27
    v_and_b32 v87, 0xffff0000, v27
    v_add_f32 v8, v8, v80
    v_add_f32 v9, v9, v81
    v_add_f32 v10, v10, v82
    v_add_f32 v11, v11, v83
    v_add_f32 v12, v12, v84
    v_add_f32 v13, v13, v85
    v_add_f32 v14, v14, v86
    v_add_f32 v15, v15, v87
    s_waitcnt vmcnt(10)
    v_lshlrev_b32 v80, 16, v28
    v_and_b32 v81, 0xffff0000, v28
    v_lshlrev_b32 v82, 16, v29
    v_and_b32 v83, 0xffff0000, v29
    v_lshlrev_b32 v84, 16, v30
    v_and_b32 v85, 0xffff0000, v30
    v_lshlrev_b32 v86, 16, v31
    v_and_b32 v87, 0xffff0000, v31
    v_add_f32 v8, v8, v80
    v_add_f32 v9, v9, v81
    v_add_f32 v10, v10, v82
    v_add_f32 v11, v11, v83
    v_add_f32 v12, v12, v84
    v_add_f32 v13, v13, v85
    v_add_f32 v14, v14, v86
    v_add_f32 v15, v15, v87
    s_waitcnt vmcnt(9)
    v_lshlrev_b32 v80, 16, v32
    v_and_b32 v81, 0xffff0000, v32
    v_lshlrev_b32 v82, 16, v33
    v_and_b32 v83, 0xffff0000, v33
    v_lshlrev_b32 v84, 16, v34
    v_and_b32 v85, 0xffff0000, v34
    v_lshlrev_b32 v86, 16, v35
    v_and_b32 v87, 0xffff0000, v35
    v_add_f32 v8, v8, v80
    v_add_f32 v9, v9, v81
    v_add_f32 v10, v10, v82
    v_add_f32 v11, v11, v83
    v_add_f32 v12, v12, v84
    v_add_f32 v13, v13, v85
    v_add_f32 v14, v14, v86
    v_add_f32 v15, v15, v87
    s_waitcnt vmcnt(8)
    v_lshlrev_b32 v80, 16, v36
    v_and_b32 v81, 0xffff0000, v36
    v_lshlrev_b32 v82, 16, v37
    v_and_b32 v83, 0xffff0000, v37
    v_lshlrev_b32 v84, 16, v38
    v_and_b32 v85, 0xffff0000, v38
    v_lshlrev_b32 v86, 16, v39
    v_and_b32 v87, 0xffff0000, v39
    v_add_f32 v8, v8, v80
    v_add_f32 v9, v9, v81
    v_add_f32 v10, v10, v82
    v_add_f32 v11, v11, v83
    v_add_f32 v12, v12, v84
    v_add_f32 v13, v13, v85
    v_add_f32 v14, v14, v86
    v_add_f32 v15, v15, v87
    s_waitcnt vmcnt(7)
    v_lshlrev_b32 v80, 16, v40
    v_and_b32 v81, 0xffff0000, v40
    v_lshlrev_b32 v82, 16, v41
    v_and_b32 v83, 0xffff0000, v41
    v_lshlrev_b32 v84, 16, v42
    v_and_b32 v85, 0xffff0000, v42
    v_lshlrev_b32 v86, 16, v43
    v_and_b32 v87, 0xffff0000, v43
    v_add_f32 v8, v8, v80
    v_add_f32 v9, v9, v81
    v_add_f32 v10, v10, v82
    v_add_f32 v11, v11, v83
    v_add_f32 v12, v12, v84
    v_add_f32 v13, v13, v85
    v_add_f32 v14, v14, v86
    v_add_f32 v15, v15, v87
    s_waitcnt vmcnt(6)
    v_lshlrev_b32 v80, 16, v44
    v_and_b32 v81, 0xffff0000, v44
    v_lshlrev_b32 v82, 16, v45
    v_and_b32 v83, 0xffff0000, v45
    v_lshlrev_b32 v84, 16, v46
    v_and_b32 v85, 0xffff0000, v46
    v_lshlrev_b32 v86, 16, v47
    v_and_b32 v87, 0xffff0000, v47
    v_add_f32 v8, v8, v80
    v_add_f32 v9, v9, v81
    v_add_f32 v10, v10, v82
    v_add_f32 v11, v11, v83
    v_add_f32 v12, v12, v84
    v_add_f32 v13, v13, v85
    v_add_f32 v14, v14, v86
    v_add_f32 v15, v15, v87
    s_waitcnt vmcnt(5)
    v_lshlrev_b32 v80, 16, v48
    v_and_b32 v81, 0xffff0000, v48
    v_lshlrev_b32 v82, 16, v49
    v_and_b32 v83, 0xffff0000, v49
    v_lshlrev_b32 v84, 16, v50
    v_and_b32 v85, 0xffff0000, v50
    v_lshlrev_b32 v86, 16, v51
    v_and_b32 v87, 0xffff0000, v51
    v_add_f32 v8, v8, v80
    v_add_f32 v9, v9, v81
    v_add_f32 v10, v10, v82
    v_add_f32 v11, v11, v83
    v_add_f32 v12, v12, v84
    v_add_f32 v13, v13, v85
    v_add_f32 v14, v14, v86
    v_add_f32 v15, v15, v87
    s_waitcnt vmcnt(4)
    v_lshlrev_b32 v80, 16, v52
    v_and_b32 v81, 0xffff0000, v52
    v_lshlrev_b32 v82, 16, v53
    v_and_b32 v83, 0xffff0000, v53
    v_lshlrev_b32 v84, 16, v54
    v_and_b32 v85, 0xffff0000, v54
    v_lshlrev_b32 v86, 16, v55
    v_and_b32 v87, 0xffff0000, v55
    v_add_f32 v8, v8, v80
    v_add_f32 v9, v9, v81
    v_add_f32 v10, v10, v82
    v_add_f32 v11, v11, v83
    v_add_f32 v12, v12, v84
    v_add_f32 v13, v13, v85
    v_add_f32 v14, v14, v86
    v_add_f32 v15, v15, v87
    s_waitcnt vmcnt(3)
    v_lshlrev_b32 v80, 16, v56
    v_and_b32 v81, 0xffff0000, v56
    v_lshlrev_b32 v82, 16, v57
    v_and_b32 v83, 0xffff0000, v57
    v_lshlrev_b32 v84, 16, v58
    v_and_b32 v85, 0xffff0000, v58
    v_lshlrev_b32 v86, 16, v59
    v_and_b32 v87, 0xffff0000, v59
    v_add_f32 v8, v8, v80
    v_add_f32 v9, v9, v81
    v_add_f32 v10, v10, v82
    v_add_f32 v11, v11, v83
    v_add_f32 v12, v12, v84
    v_add_f32 v13, v13, v85
    v_add_f32 v14, v14, v86
    v_add_f32 v15, v15, v87
    s_waitcnt vmcnt(2)
    v_lshlrev_b32 v80, 16, v60
    v_and_b32 v81, 0xffff0000, v60
    v_lshlrev_b32 v82, 16, v61
    v_and_b32 v83, 0xffff0000, v61
    v_lshlrev_b32 v84, 16, v62
    v_and_b32 v85, 0xffff0000, v62
    v_lshlrev_b32 v86, 16, v63
    v_and_b32 v87, 0xffff0000, v63
    v_add_f32 v8, v8, v80
    v_add_f32 v9, v9, v81
    v_add_f32 v10, v10, v82
    v_add_f32 v11, v11, v83
    v_add_f32 v12, v12, v84
    v_add_f32 v13, v13, v85
    v_add_f32 v14, v14, v86
    v_add_f32 v15, v15, v87
    s_waitcnt vmcnt(1)
    v_lshlrev_b32 v80, 16, v64
    v_and_b32 v81, 0xffff0000, v64
    v_lshlrev_b32 v82, 16, v65
    v_and_b32 v83, 0xffff0000, v65
    v_lshlrev_b32 v84, 16, v66
    v_and_b32 v85, 0xffff0000, v66
    v_lshlrev_b32 v86, 16, v67
    v_and_b32 v87, 0xffff0000, v67
    v_add_f32 v8, v8, v80
    v_add_f32 v9, v9, v81
    v_add_f32 v10, v10, v82
    v_add_f32 v11, v11, v83
    v_add_f32 v12, v12, v84
    v_add_f32 v13, v13, v85
    v_add_f32 v14, v14, v86
    v_add_f32 v15, v15, v87
    s_waitcnt vmcnt(0)
    v_lshlrev_b32 v80, 16, v68
    v_and_b32 v81, 0xffff0000, v68
    v_lshlrev_b32 v82, 16, v69
    v_and_b32 v83, 0xffff0000, v69
    v_lshlrev_b32 v84, 16, v70
    v_and_b32 v85, 0xffff0000, v70
    v_lshlrev_b32 v86, 16, v71
    v_and_b32 v87, 0xffff0000, v71
    v_add_f32 v8, v8, v80
    v_add_f32 v9, v9, v81
    v_add_f32 v10, v10, v82
    v_add_f32 v11, v11, v83
    v_add_f32 v12, v12, v84
    v_add_f32 v13, v13, v85
    v_add_f32 v14, v14, v86
    v_add_f32 v15, v15, v87
    ds_write_b128 v4, v[8:11]
    ds_write_b128 v4, v[12:15] offset:16
    s_waitcnt lgkmcnt(0)
    s_barrier
    v_cmp_gt_u32 vcc, 64, v0
    s_nop 0
    s_and_saveexec_b64 s[12:13], vcc
    s_cbranch_execz K1_exit
    ds_read_b32 v16, v5 offset:0
    ds_read_b32 v17, v5 offset:256
    ds_read_b32 v18, v5 offset:512
    ds_read_b32 v19, v5 offset:768
    ds_read_b32 v20, v5 offset:1024
    ds_read_b32 v21, v5 offset:1280
    ds_read_b32 v22, v5 offset:1536
    ds_read_b32 v23, v5 offset:1792
    ds_read_b32 v24, v5 offset:2048
    ds_read_b32 v25, v5 offset:2304
    ds_read_b32 v26, v5 offset:2560
    ds_read_b32 v27, v5 offset:2816
    ds_read_b32 v28, v5 offset:3072
    ds_read_b32 v29, v5 offset:3328
    ds_read_b32 v30, v5 offset:3584
    ds_read_b32 v31, v5 offset:3840
    ds_read_b32 v32, v5 offset:4096
    ds_read_b32 v33, v5 offset:4352
    ds_read_b32 v34, v5 offset:4608
    ds_read_b32 v35, v5 offset:4864
    ds_read_b32 v36, v5 offset:5120
    ds_read_b32 v37, v5 offset:5376
    ds_read_b32 v38, v5 offset:5632
    ds_read_b32 v39, v5 offset:5888
    ds_read_b32 v40, v5 offset:6144
    ds_read_b32 v41, v5 offset:6400
    ds_read_b32 v42, v5 offset:6656
    ds_read_b32 v43, v5 offset:6912
    ds_read_b32 v44, v5 offset:7168
    ds_read_b32 v45, v5 offset:7424
    ds_read_b32 v46, v5 offset:7680
    ds_read_b32 v47, v5 offset:7936
    s_lshl_b32 s4, s3, 8
    s_add_u32 s4, s4, 12451840
    v_add_u32 v5, s4, v5
    s_waitcnt lgkmcnt(0)
    v_add_f32 v16, v16, v32
    v_add_f32 v17, v17, v33
    v_add_f32 v18, v18, v34
    v_add_f32 v19, v19, v35
    v_add_f32 v20, v20, v36
    v_add_f32 v21, v21, v37
    v_add_f32 v22, v22, v38
    v_add_f32 v23, v23, v39
    v_add_f32 v24, v24, v40
    v_add_f32 v25, v25, v41
    v_add_f32 v26, v26, v42
    v_add_f32 v27, v27, v43
    v_add_f32 v28, v28, v44
    v_add_f32 v29, v29, v45
    v_add_f32 v30, v30, v46
    v_add_f32 v31, v31, v47
    v_add_f32 v16, v16, v24
    v_add_f32 v17, v17, v25
    v_add_f32 v18, v18, v26
    v_add_f32 v19, v19, v27
    v_add_f32 v20, v20, v28
    v_add_f32 v21, v21, v29
    v_add_f32 v22, v22, v30
    v_add_f32 v23, v23, v31
    v_add_f32 v16, v16, v20
    v_add_f32 v17, v17, v21
    v_add_f32 v18, v18, v22
    v_add_f32 v19, v19, v23
    v_add_f32 v16, v16, v18
    v_add_f32 v17, v17, v19
    v_add_f32 v16, v16, v17
    v_lshlrev_b32 v7, 16, v7
    v_add_u32 v6, 8192, v5
    global_store_dword v5, v16, s[40:41] sc0 sc1
    global_store_dword v6, v7, s[40:41] sc0 sc1
    s_endpgm
.globl k3_mlp_kernel
.p2align 8
.type k3_mlp_kernel,@function
k3_mlp_kernel:
    s_cmp_ge_u32 s2, 256
    s_cbranch_scc1 K3_exit
    s_cmp_lt_u32 s2, 32
    s_cbranch_scc1 K3_helper
    s_sub_u32 s2, s2, 32
    s_load_dwordx2 s[40:41], s[0:1], 112
    s_load_dwordx2 s[28:29], s[0:1], 48
    s_load_dwordx4 s[36:39], s[0:1], 88
    v_lshrrev_b32 v1, 6, v0
    v_and_b32 v2, 63, v0
    v_readfirstlane_b32 s27, v1
    v_and_b32 v142, 255, v0
    s_and_b32 s4, s27, 3
    s_lshr_b32 s22, s27, 2
    s_lshl_b32 s23, s2, 1
    s_add_u32 s23, s23, s22
    s_mul_i32 s24, s22, 75776
    s_mul_i32 s5, s23, 4160
    s_mul_i32 s6, s23, 4160
    s_add_u32 s6, s6, 5701632
    v_lshlrev_b32 v3, 4, v142
    v_add_u32 v4, s5, v3
    v_add_u32 v5, s6, v3
    s_waitcnt lgkmcnt(0)
    s_add_u32 s8, s40, s6
    s_addc_u32 s9, s41, 0
    s_load_dword s10, s[8:9], 4096
    s_lshl_b32 s17, s2, 2
    s_load_dword s16, s[28:29], s17
    global_load_dwordx4 v[8:11], v4, s[40:41]
    global_load_dwordx4 v[12:15], v4, s[40:41] offset:16
    global_load_dwordx4 v[16:19], v5, s[40:41]
    s_mul_i32 s15, s23, 4352
    v_add_u32 v7, s15, v3
    v_add_u32 v64, 1900544, v7
    v_add_u32 v7, 12517376, v7
    global_load_dwordx4 v[24:27], v64, s[40:41]
    s_and_b32 s25, s2, 7
    s_lshr_b32 s26, s2, 3
    s_mul_i32 s18, s26, 37
    s_lshr_b32 s18, s18, 8
    s_mul_i32 s19, s18, 7
    s_sub_u32 s26, s26, s19
    s_lshl_b32 s25, s25, 2
    s_add_u32 s25, s25, s18
    s_lshl_b32 s30, s26, 3
    s_add_u32 s30, s30, s27
    s_add_u32 s12, s18, 0
    s_and_b32 s12, s12, 3
    s_mul_i32 s48, s12, 7168
    s_add_u32 s49, s48, 4096
    s_add_u32 s12, s18, 1
    s_and_b32 s12, s12, 3
    s_mul_i32 s50, s12, 7168
    s_add_u32 s51, s50, 4096
    s_add_u32 s12, s18, 2
    s_and_b32 s12, s12, 3
    s_mul_i32 s52, s12, 7168
    s_add_u32 s53, s52, 4096
    s_add_u32 s12, s18, 3
    s_and_b32 s12, s12, 3
    s_mul_i32 s54, s12, 7168
    s_add_u32 s55, s54, 4096
    s_mov_b32 s44, s40
    s_and_b32 s45, s41, 0xffff
    s_mov_b32 s46, 22085632
    s_mov_b32 s47, 0x00020000
    s_mul_i32 s12, s30, 28672
    s_add_u32 s12, s12, 9175040
    v_lshl_add_u32 v143, v2, 4, s12
    s_mul_i32 s12, s25, 224
    s_lshl_b32 s13, s30, 1
    s_add_u32 s12, s12, s13
    s_lshl_b32 s12, s12, 10
    s_add_u32 s12, s12, 14483456
    v_lshl_add_u32 v130, v2, 4, s12
    v_add_u32 v131, 114688, v130
    v_mov_b32 v132, -1
    v_mov_b32 v133, -1
    v_mov_b32 v134, -1
    v_mov_b32 v135, -1
    s_lshr_b32 s12, s2, 3
    s_lshl_b32 s12, s12, 3
    s_add_u32 s12, s12, s27
    s_mul_i32 s12, s12, 7168
    s_add_u32 s12, s12, 10813440
    v_lshl_add_u32 v139, v2, 4, s12
    s_mov_b32 s63, 4096
    s_add_u32 s12, s24, 4080
    v_sub_u32 v140, s12, v3
    v_add_u32 v3, s24, v3
    v_lshrrev_b32 v141, 7, v142
    v_lshlrev_b32 v141, 2, v141
    v_and_b32 v64, 3, v142
    v_add_u32 v141, v141, v64
    v_mul_u32_u24 v141, 1088, v141
    v_bfe_u32 v64, v142, 2, 5
    v_lshl_add_u32 v141, v64, 4, v141
    s_add_u32 s12, s24, 40960
    v_add_u32 v141, s12, v141
    v_mov_b32 v68, 0
    v_mov_b32 v69, 0
    v_mov_b32 v70, 0
    v_mov_b32 v71, 0
    v_lshrrev_b32 v66, 2, v142
    v_mul_u32_u24 v66, 4160, v66
    v_and_b32 v67, 3, v142
    v_lshl_add_u32 v66, v67, 4, v66
    v_add_u32 v66, s24, v66
    s_cmp_lg_u32 s4, 0
    s_cbranch_scc1 K2_nz
    v_cmp_gt_u32 vcc, 32, v142
    s_nop 0
    s_and_saveexec_b64 s[12:13], vcc
    ds_write_b128 v66, v[68:71] offset:4096
    s_mov_b64 exec, s[12:13]
K2_nz:
    v_cmp_gt_u32 vcc, 155, v142
    s_nop 0
    s_and_saveexec_b64 s[12:13], vcc
    s_cbranch_execz K2_nz2
    ds_write_b128 v3, v[68:71] offset:33280
K2_nz2:
    s_mov_b64 exec, s[12:13]
    v_lshrrev_b32 v6, 2, v142
    v_lshl_add_u32 v6, v6, 4, v3
    v_cmp_eq_u32 vcc, 255, v142
    s_waitcnt vmcnt(2)
    s_nop 0
    v_cndmask_b32_e64 v12, v12, 0, vcc
    v_cndmask_b32_e64 v13, v13, 0, vcc
    v_cndmask_b32_e64 v14, v14, 0, vcc
    v_cndmask_b32_e64 v15, v15, 0, vcc
    buffer_load_dwordx4 v[144:147], v143, s[44:47], s48 offen offset:0
    buffer_load_dwordx4 v[148:151], v143, s[44:47], s48 offen offset:1024
    ds_write_b128 v3, v[8:11] offset:0
    v_alignbyte_b32 v76, v9, v8, 2
    v_alignbyte_b32 v77, v10, v9, 2
    v_alignbyte_b32 v78, v11, v10, 2
    v_alignbyte_b32 v79, v12, v11, 2
    ds_write_b128 v3, v[76:79] offset:4160
    v_mov_b32 v72, v9
    v_mov_b32 v73, v10
    v_mov_b32 v74, v11
    v_mov_b32 v75, v12
    ds_write_b128 v3, v[72:75] offset:8320
    v_alignbyte_b32 v80, v10, v9, 2
    v_alignbyte_b32 v81, v11, v10, 2
    v_alignbyte_b32 v82, v12, v11, 2
    v_alignbyte_b32 v83, v13, v12, 2
    ds_write_b128 v3, v[80:83] offset:12480
    ds_write_b128 v3, v[10:13] offset:16640
    v_alignbyte_b32 v76, v11, v10, 2
    v_alignbyte_b32 v77, v12, v11, 2
    v_alignbyte_b32 v78, v13, v12, 2
    v_alignbyte_b32 v79, v14, v13, 2
    ds_write_b128 v3, v[76:79] offset:20800
    v_mov_b32 v72, v11
    v_mov_b32 v73, v12
    v_mov_b32 v74, v13
    v_mov_b32 v75, v14
    ds_write_b128 v3, v[72:75] offset:24960
    v_alignbyte_b32 v80, v12, v11, 2
    v_alignbyte_b32 v81, v13, v12, 2
    v_alignbyte_b32 v82, v14, v13, 2
    v_alignbyte_b32 v83, v15, v14, 2
    ds_write_b128 v3, v[80:83] offset:29120
    s_waitcnt vmcnt(3)
    ds_write_b128 v6, v[16:19] offset:35760
    buffer_load_dwordx4 v[152:155], v143, s[44:47], s48 offen offset:2048
    buffer_load_dwordx4 v[156:159], v143, s[44:47], s48 offen offset:3072
    v_and_b32 v64, 7, v2
    v_sub_u32 v64, 7, v64
    v_mul_u32_u24 v64, 4160, v64
    v_add_u32 v64, s24, v64
    v_lshrrev_b32 v65, 5, v2
    v_bfe_u32 v66, v2, 3, 2
    v_sub_u32 v66, v65, v66
    s_lshl_b32 s14, s4, 1
    s_sub_u32 s14, 9, s14
    v_add_u32 v66, s14, v66
    v_lshl_add_u32 v4, v66, 4, v64
    s_lshr_b32 s14, s4, 1
    s_sub_u32 s14, 1, s14
    s_mul_i32 s14, s14, 80
    s_and_b32 s15, s4, 1
    s_xor_b32 s15, s15, 1
    s_lshl_b32 s15, s15, 5
    s_add_u32 s14, s14, s15
    s_add_u32 s14, s14, 33280
    s_add_u32 s14, s14, s24
    v_and_b32 v64, 31, v2
    v_mul_u32_u24 v64, 80, v64
    v_lshl_add_u32 v64, v65, 4, v64
    v_add_u32 v5, s14, v64
    s_waitcnt lgkmcnt(0)
    s_barrier
    ds_read_b128 v[72:75], v4 offset:3968
    ds_read_b128 v[80:83], v5 offset:4960
    ds_read_b128 v[76:79], v4 offset:1920
    ds_read_b128 v[84:87], v5 offset:2400
    ds_read_b128 v[88:91], v4 offset:3840
    ds_read_b128 v[96:99], v5 offset:4800
    ds_read_b128 v[92:95], v4 offset:1792
    ds_read_b128 v[100:103], v5 offset:2240
    ds_read_b128 v[104:107], v4 offset:3712
    ds_read_b128 v[112:115], v5 offset:4640
    ds_read_b128 v[108:111], v4 offset:1664
    ds_read_b128 v[116:119], v5 offset:2080
    s_waitcnt lgkmcnt(8)
    v_mfma_f32_32x32x16_f16 v[48:63], v[72:75], v[80:83], 0
    v_mfma_f32_32x32x16_f16 v[32:47], v[72:75], v[84:87], 0
    v_mfma_f32_32x32x16_f16 v[48:63], v[76:79], v[84:87], v[48:63]
    buffer_load_dwordx4 v[160:163], v143, s[44:47], s49 offen offset:0
    ds_read_b128 v[72:75], v4 offset:3584
    ds_read_b128 v[80:83], v5 offset:4480
    ds_read_b128 v[76:79], v4 offset:1536
    ds_read_b128 v[84:87], v5 offset:1920
    s_waitcnt lgkmcnt(8)
    v_mfma_f32_32x32x16_f16 v[48:63], v[88:91], v[96:99], v[48:63]
    v_mfma_f32_32x32x16_f16 v[32:47], v[88:91], v[100:103], v[32:47]
    v_mfma_f32_32x32x16_f16 v[48:63], v[92:95], v[100:103], v[48:63]
    ds_read_b128 v[88:91], v4 offset:3456
    ds_read_b128 v[96:99], v5 offset:4320
    ds_read_b128 v[92:95], v4 offset:1408
    ds_read_b128 v[100:103], v5 offset:1760
    s_waitcnt lgkmcnt(8)
    v_mfma_f32_32x32x16_f16 v[48:63], v[104:107], v[112:115], v[48:63]
    v_mfma_f32_32x32x16_f16 v[32:47], v[104:107], v[116:119], v[32:47]
    v_mfma_f32_32x32x16_f16 v[48:63], v[108:111], v[116:119], v[48:63]
    buffer_load_dwordx4 v[164:167], v143, s[44:47], s49 offen offset:1024
    ds_read_b128 v[104:107], v4 offset:3328
    ds_read_b128 v[112:115], v5 offset:4160
    ds_read_b128 v[108:111], v4 offset:1280
    ds_read_b128 v[116:119], v5 offset:1600
    s_waitcnt lgkmcnt(8)
    v_mfma_f32_32x32x16_f16 v[48:63], v[72:75], v[80:83], v[48:63]
    v_mfma_f32_32x32x16_f16 v[32:47], v[72:75], v[84:87], v[32:47]
    v_mfma_f32_32x32x16_f16 v[48:63], v[76:79], v[84:87], v[48:63]
    ds_read_b128 v[72:75], v4 offset:3200
    ds_read_b128 v[80:83], v5 offset:4000
    ds_read_b128 v[76:79], v4 offset:1152
    ds_read_b128 v[84:87], v5 offset:1440
    s_waitcnt lgkmcnt(8)
    v_mfma_f32_32x32x16_f16 v[48:63], v[88:91], v[96:99], v[48:63]
    v_mfma_f32_32x32x16_f16 v[32:47], v[88:91], v[100:103], v[32:47]
    v_mfma_f32_32x32x16_f16 v[48:63], v[92:95], v[100:103], v[48:63]
    buffer_load_dwordx4 v[168:171], v143, s[44:47], s49 offen offset:2048
    ds_read_b128 v[88:91], v4 offset:3072
    ds_read_b128 v[96:99], v5 offset:3840
    ds_read_b128 v[92:95], v4 offset:1024
    ds_read_b128 v[100:103], v5 offset:1280
    s_waitcnt lgkmcnt(8)
    v_mfma_f32_32x32x16_f16 v[48:63], v[104:107], v[112:115], v[48:63]
    v_mfma_f32_32x32x16_f16 v[32:47], v[104:107], v[116:119], v[32:47]
    v_mfma_f32_32x32x16_f16 v[48:63], v[108:111], v[116:119], v[48:63]
    ds_read_b128 v[104:107], v4 offset:2944
    ds_read_b128 v[112:115], v5 offset:3680
    ds_read_b128 v[108:111], v4 offset:896
    ds_read_b128 v[116:119], v5 offset:1120
    s_waitcnt lgkmcnt(8)
    v_mfma_f32_32x32x16_f16 v[48:63], v[72:75], v[80:83], v[48:63]
    v_mfma_f32_32x32x16_f16 v[32:47], v[72:75], v[84:87], v[32:47]
    v_mfma_f32_32x32x16_f16 v[48:63], v[76:79], v[84:87], v[48:63]
    buffer_load_dwordx4 v[16:19], v139, s[44:47], 0 offen offset:0
    buffer_load_dwordx4 v[172:175], v143, s[44:47], s50 offen offset:0
    ds_read_b128 v[72:75], v4 offset:2816
    ds_read_b128 v[80:83], v5 offset:3520
    ds_read_b128 v[76:79], v4 offset:768
    ds_read_b128 v[84:87], v5 offset:960
    s_waitcnt lgkmcnt(8)
    v_mfma_f32_32x32x16_f16 v[48:63], v[88:91], v[96:99], v[48:63]
    v_mfma_f32_32x32x16_f16 v[32:47], v[88:91], v[100:103], v[32:47]
    v_mfma_f32_32x32x16_f16 v[48:63], v[92:95], v[100:103], v[48:63]
    buffer_load_dwordx4 v[176:179], v143, s[44:47], s50 offen offset:1024
    buffer_load_dwordx4 v[180:183], v143, s[44:47], s50 offen offset:2048
    ds_read_b128 v[88:91], v4 offset:2688
    ds_read_b128 v[96:99], v5 offset:3360
    ds_read_b128 v[92:95], v4 offset:640
    ds_read_b128 v[100:103], v5 offset:800
    s_waitcnt lgkmcnt(8)
    v_mfma_f32_32x32x16_f16 v[48:63], v[104:107], v[112:115], v[48:63]
    v_mfma_f32_32x32x16_f16 v[32:47], v[104:107], v[116:119], v[32:47]
    v_mfma_f32_32x32x16_f16 v[48:63], v[108:111], v[116:119], v[48:63]
    buffer_load_dwordx4 v[16:19], v139, s[44:47], 0 offen offset:1024
    buffer_load_dwordx4 v[184:187], v143, s[44:47], s50 offen offset:3072
    ds_read_b128 v[104:107], v4 offset:2560
    ds_read_b128 v[112:115], v5 offset:3200
    ds_read_b128 v[108:111], v4 offset:512
    ds_read_b128 v[116:119], v5 offset:640
    s_waitcnt lgkmcnt(8)
    v_mfma_f32_32x32x16_f16 v[48:63], v[72:75], v[80:83], v[48:63]
    v_mfma_f32_32x32x16_f16 v[32:47], v[72:75], v[84:87], v[32:47]
    v_mfma_f32_32x32x16_f16 v[48:63], v[76:79], v[84:87], v[48:63]
    buffer_load_dwordx4 v[188:191], v143, s[44:47], s51 offen offset:0
    buffer_load_dwordx4 v[192:195], v143, s[44:47], s51 offen offset:1024
    ds_read_b128 v[72:75], v4 offset:2432
    ds_read_b128 v[80:83], v5 offset:3040
    ds_read_b128 v[76:79], v4 offset:384
    ds_read_b128 v[84:87], v5 offset:480
    s_waitcnt lgkmcnt(8)
    v_mfma_f32_32x32x16_f16 v[48:63], v[88:91], v[96:99], v[48:63]
    v_mfma_f32_32x32x16_f16 v[32:47], v[88:91], v[100:103], v[32:47]
    v_mfma_f32_32x32x16_f16 v[48:63], v[92:95], v[100:103], v[48:63]
    buffer_load_dwordx4 v[16:19], v139, s[44:47], 0 offen offset:2048
    buffer_load_dwordx4 v[196:199], v143, s[44:47], s51 offen offset:2048
    v_and_b32 v136, 31, v2
    v_lshlrev_b32 v136, 7, v136
    v_add_u32 v136, 21823552, v136
    global_load_dword v137, v136, s[40:41] sc1
    ds_read_b128 v[88:91], v4 offset:2304
    ds_read_b128 v[96:99], v5 offset:2880
    ds_read_b128 v[92:95], v4 offset:256
    ds_read_b128 v[100:103], v5 offset:320
    s_waitcnt lgkmcnt(8)
    v_mfma_f32_32x32x16_f16 v[48:63], v[104:107], v[112:115], v[48:63]
    v_mfma_f32_32x32x16_f16 v[32:47], v[104:107], v[116:119], v[32:47]
    v_mfma_f32_32x32x16_f16 v[48:63], v[108:111], v[116:119], v[48:63]
    buffer_load_dwordx4 v[200:203], v143, s[44:47], s52 offen offset:0
    buffer_load_dwordx4 v[204:207], v143, s[44:47], s52 offen offset:1024
    ds_read_b128 v[104:107], v4 offset:2176
    ds_read_b128 v[112:115], v5 offset:2720
    ds_read_b128 v[108:111], v4 offset:128
    ds_read_b128 v[116:119], v5 offset:160
    s_waitcnt lgkmcnt(8)
    v_mfma_f32_32x32x16_f16 v[48:63], v[72:75], v[80:83], v[48:63]
    v_mfma_f32_32x32x16_f16 v[32:47], v[72:75], v[84:87], v[32:47]
    v_mfma_f32_32x32x16_f16 v[48:63], v[76:79], v[84:87], v[48:63]
    buffer_load_dwordx4 v[16:19], v139, s[44:47], 0 offen offset:3072
    buffer_load_dwordx4 v[208:211], v143, s[44:47], s52 offen offset:2048
    ds_read_b128 v[72:75], v4 offset:2048
    ds_read_b128 v[80:83], v5 offset:2560
    ds_read_b128 v[76:79], v4 offset:0
    ds_read_b128 v[84:87], v5 offset:0
    s_waitcnt lgkmcnt(8)
    v_mfma_f32_32x32x16_f16 v[48:63], v[88:91], v[96:99], v[48:63]
    v_mfma_f32_32x32x16_f16 v[32:47], v[88:91], v[100:103], v[32:47]
    v_mfma_f32_32x32x16_f16 v[48:63], v[92:95], v[100:103], v[48:63]
    buffer_load_dwordx4 v[212:215], v143, s[44:47], s52 offen offset:3072
    buffer_load_dwordx4 v[216:219], v143, s[44:47], s53 offen offset:0
    s_waitcnt lgkmcnt(4)
    v_mfma_f32_32x32x16_f16 v[48:63], v[104:107], v[112:115], v[48:63]
    v_mfma_f32_32x32x16_f16 v[32:47], v[104:107], v[116:119], v[32:47]
    v_mfma_f32_32x32x16_f16 v[48:63], v[108:111], v[116:119], v[48:63]
    buffer_load_dwordx4 v[16:19], v139, s[44:47], s63 offen offset:0
    buffer_load_dwordx4 v[220:223], v143, s[44:47], s53 offen offset:1024
    s_waitcnt lgkmcnt(0)
    v_mfma_f32_32x32x16_f16 v[48:63], v[72:75], v[80:83], v[48:63]
    v_mfma_f32_32x32x16_f16 v[32:47], v[72:75], v[84:87], v[32:47]
    v_mfma_f32_32x32x16_f16 v[48:63], v[76:79], v[84:87], v[48:63]
    buffer_load_dwordx4 v[224:227], v143, s[44:47], s53 offen offset:2048
    buffer_load_dwordx4 v[228:231], v143, s[44:47], s54 offen offset:0
    s_mul_i32 s14, s4, 8704
    s_add_u32 s14, s14, 40960
    s_add_u32 s14, s14, s24
    v_lshlrev_b32 v64, 4, v2
    v_add_u32 v65, s14, v64
    s_nop 3
    ds_write_b128 v65, v[32:35] offset:0
    ds_write_b128 v65, v[36:39] offset:1088
    ds_write_b128 v65, v[40:43] offset:2176
    ds_write_b128 v65, v[44:47] offset:3264
    ds_write_b128 v65, v[48:51] offset:4352
    ds_write_b128 v65, v[52:55] offset:5440
    ds_write_b128 v65, v[56:59] offset:6528
    ds_write_b128 v65, v[60:63] offset:7616
    s_waitcnt vmcnt(28)
    s_waitcnt lgkmcnt(0)
    s_barrier
    ds_read_b128 v[132:135], v140
    ds_read_b128 v[72:75], v141 offset:0
    ds_read_b128 v[76:79], v141 offset:512
    ds_read_b128 v[80:83], v141 offset:8704
    ds_read_b128 v[84:87], v141 offset:9216
    ds_read_b128 v[88:91], v141 offset:17408
    ds_read_b128 v[92:95], v141 offset:17920
    ds_read_b128 v[96:99], v141 offset:26112
    ds_read_b128 v[100:103], v141 offset:26624
    s_lshl_b32 s17, s22, 4
    s_lshr_b32 s16, s16, s17
    s_lshl_b32 s16, s16, 16
    s_waitcnt lgkmcnt(8)
    v_fma_mix_f32 v32, v135, s16, 0 op_sel:[1,0,0] op_sel_hi:[1,0,0]
    v_fma_mix_f32 v33, v135, s16, 0 op_sel:[0,0,0] op_sel_hi:[1,0,0]
    v_fma_mix_f32 v34, v134, s16, 0 op_sel:[1,0,0] op_sel_hi:[1,0,0]
    v_fma_mix_f32 v35, v134, s16, 0 op_sel:[0,0,0] op_sel_hi:[1,0,0]
    v_fma_mix_f32 v36, v133, s16, 0 op_sel:[1,0,0] op_sel_hi:[1,0,0]
    v_fma_mix_f32 v37, v133, s16, 0 op_sel:[0,0,0] op_sel_hi:[1,0,0]
    v_fma_mix_f32 v38, v132, s16, 0 op_sel:[1,0,0] op_sel_hi:[1,0,0]
    v_fma_mix_f32 v39, v132, s16, 0 op_sel:[0,0,0] op_sel_hi:[1,0,0]
    v_cvt_pk_bf16_f32 v28, v32, v33
    v_cvt_pk_bf16_f32 v29, v34, v35
    v_cvt_pk_bf16_f32 v30, v36, v37
    v_cvt_pk_bf16_f32 v31, v38, v39
    v_lshlrev_b32 v32, 16, v28
    v_and_b32 v33, 0xffff0000, v28
    v_lshlrev_b32 v34, 16, v29
    v_and_b32 v35, 0xffff0000, v29
    v_lshlrev_b32 v36, 16, v30
    v_and_b32 v37, 0xffff0000, v30
    v_lshlrev_b32 v38, 16, v31
    v_and_b32 v39, 0xffff0000, v31
    v_lshlrev_b32 v48, 16, v24
    v_and_b32 v49, 0xffff0000, v24
    v_lshlrev_b32 v50, 16, v25
    v_and_b32 v51, 0xffff0000, v25
    v_lshlrev_b32 v52, 16, v26
    v_and_b32 v53, 0xffff0000, v26
    v_lshlrev_b32 v54, 16, v27
    v_and_b32 v55, 0xffff0000, v27
    s_waitcnt lgkmcnt(0)
    v_mov_b32 v64, s10
    v_add_f32 v72, v72, v80
    v_add_f32 v88, v88, v96
    v_add_f32 v73, v73, v81
    v_add_f32 v89, v89, v97
    v_add_f32 v74, v74, v82
    v_add_f32 v90, v90, v98
    v_add_f32 v75, v75, v83
    v_add_f32 v91, v91, v99
    v_add_f32 v76, v76, v84
    v_add_f32 v92, v92, v100
    v_add_f32 v77, v77, v85
    v_add_f32 v93, v93, v101
    v_add_f32 v78, v78, v86
    v_add_f32 v94, v94, v102
    v_add_f32 v79, v79, v87
    v_add_f32 v95, v95, v103
    v_add_f32 v72, v72, v88
    v_add_f32 v73, v73, v89
    v_add_f32 v74, v74, v90
    v_add_f32 v75, v75, v91
    v_add_f32 v76, v76, v92
    v_add_f32 v77, v77, v93
    v_add_f32 v78, v78, v94
    v_add_f32 v79, v79, v95
    v_mul_f32 v72, v64, v72
    v_mul_f32 v73, v64, v73
    v_mul_f32 v74, v64, v74
    v_mul_f32 v75, v64, v75
    v_mul_f32 v76, v64, v76
    v_mul_f32 v77, v64, v77
    v_mul_f32 v78, v64, v78
    v_mul_f32 v79, v64, v79
    v_cvt_pk_bf16_f32 v80, v72, v73
    v_cvt_pk_bf16_f32 v81, v74, v75
    v_cvt_pk_bf16_f32 v82, v76, v77
    v_cvt_pk_bf16_f32 v83, v78, v79
    v_lshlrev_b32 v72, 16, v80
    v_and_b32 v73, 0xffff0000, v80
    v_lshlrev_b32 v74, 16, v81
    v_and_b32 v75, 0xffff0000, v81
    v_lshlrev_b32 v76, 16, v82
    v_and_b32 v77, 0xffff0000, v82
    v_lshlrev_b32 v78, 16, v83
    v_and_b32 v79, 0xffff0000, v83
    v_add_f32 v72, v72, v32
    v_add_f32 v73, v73, v33
    v_add_f32 v74, v74, v34
    v_add_f32 v75, v75, v35
    v_add_f32 v76, v76, v36
    v_add_f32 v77, v77, v37
    v_add_f32 v78, v78, v38
    v_add_f32 v79, v79, v39
    v_cvt_pk_bf16_f32 v80, v72, v73
    v_cvt_pk_bf16_f32 v81, v74, v75
    v_cvt_pk_bf16_f32 v82, v76, v77
    v_cvt_pk_bf16_f32 v83, v78, v79
    v_lshlrev_b32 v72, 16, v80
    v_and_b32 v73, 0xffff0000, v80
    v_lshlrev_b32 v74, 16, v81
    v_and_b32 v75, 0xffff0000, v81
    v_lshlrev_b32 v76, 16, v82
    v_and_b32 v77, 0xffff0000, v82
    v_lshlrev_b32 v78, 16, v83
    v_and_b32 v79, 0xffff0000, v83
    v_add_f32 v72, v72, v48
    v_add_f32 v73, v73, v49
    v_add_f32 v74, v74, v50
    v_add_f32 v75, v75, v51
    v_add_f32 v76, v76, v52
    v_add_f32 v77, v77, v53
    v_add_f32 v78, v78, v54
    v_add_f32 v79, v79, v55
    v_cvt_pk_bf16_f32 v88, v72, v73
    v_cvt_pk_bf16_f32 v89, v74, v75
    v_cvt_pk_bf16_f32 v90, v76, v77
    v_cvt_pk_bf16_f32 v91, v78, v79
    s_waitcnt vmcnt(10)
    v_cmp_eq_u32 vcc, 0, v137
    s_cbranch_vccnz K3_aw
K3_aok:
    global_store_dwordx4 v7, v[88:91], s[40:41] sc0 sc1
    buffer_load_dwordx4 v[16:19], v139, s[44:47], s63 offen offset:1024
    buffer_load_dwordx4 v[232:235], v143, s[44:47], s54 offen offset:1024
    buffer_load_dwordx4 v[236:239], v143, s[44:47], s54 offen offset:2048
    buffer_load_dwordx4 v[240:243], v143, s[44:47], s54 offen offset:3072
    buffer_load_dwordx4 v[16:19], v139, s[44:47], s63 offen offset:2048
    buffer_load_dwordx4 v[244:247], v143, s[44:47], s55 offen offset:0
    buffer_load_dwordx4 v[248:251], v143, s[44:47], s55 offen offset:1024
    buffer_load_dwordx4 v[252:255], v143, s[44:47], s55 offen offset:2048
    s_barrier
    s_mov_b32 s4, s27
    s_mov_b32 s5, s25
    s_mov_b32 s6, s26
    s_mov_b32 s9, s30
    s_and_b32 s10, s4, 1
    s_xor_b32 s11, s10, 1
    s_lshr_b32 s12, s4, 2
    s_lshl_b32 s12, s12, 13
    s_lshl_b32 s13, s6, 10
    s_add_u32 s12, s12, s13
    s_and_b32 s13, s4, 3
    s_lshl_b32 s13, s13, 8
    s_add_u32 s12, s12, s13
    s_add_u32 s12, s12, 12451840
    v_lshl_add_u32 v9, v2, 2, s12
    s_lshl_b32 s12, s4, 8
    s_add_u32 s12, s12, 61440
    s_mov_b32 m0, s12
    s_nop 0
    buffer_load_dword v9, s[44:47], 0 offen lds
    s_mov_b32 s12, s6
    s_add_u32 s12, s12, 1
    s_cmp_eq_u32 s12, 7
    s_cselect_b32 s12, 0, s12
    s_lshl_b32 s56, s12, 14
    s_add_u32 s12, s12, 1
    s_cmp_eq_u32 s12, 7
    s_cselect_b32 s12, 0, s12
    s_lshl_b32 s57, s12, 14
    s_add_u32 s12, s12, 1
    s_cmp_eq_u32 s12, 7
    s_cselect_b32 s12, 0, s12
    s_lshl_b32 s58, s12, 14
    s_add_u32 s12, s12, 1
    s_cmp_eq_u32 s12, 7
    s_cselect_b32 s12, 0, s12
    s_lshl_b32 s59, s12, 14
    s_add_u32 s12, s12, 1
    s_cmp_eq_u32 s12, 7
    s_cselect_b32 s12, 0, s12
    s_lshl_b32 s60, s12, 14
    s_add_u32 s12, s12, 1
    s_cmp_eq_u32 s12, 7
    s_cselect_b32 s12, 0, s12
    s_lshl_b32 s61, s12, 14
    s_lshl_b32 s62, s6, 14
    v_lshrrev_b32 v3, 3, v2
    v_lshrrev_b32 v4, 2, v2
    v_lshrrev_b32 v5, 4, v2
    v_xor_b32 v4, v4, v5
    v_and_b32 v4, 1, v4
    v_mul_u32_u24 v5, 4352, v3
    v_lshl_add_u32 v5, v4, 6, v5
    v_and_b32 v4, 3, v2
    v_lshl_add_u32 v5, v4, 4, v5
    s_lshl_b32 s12, s5, 7
    s_add_u32 s12, s12, 12517376
    v_add_u32 v5, s12, v5
    s_lshl_b32 s13, s4, 10
    s_mul_i32 s14, s4, 34816
    v_lshl_add_u32 v6, v2, 4, s13
    s_mul_i32 s12, s6, 229376
    s_lshl_b32 s15, s4, 11
    s_add_u32 s12, s12, s15
    s_add_u32 s12, s12, 10813440
    v_lshl_add_u32 v13, v2, 4, s12
    v_add_u32 v14, 114688, v13
    s_mul_i32 s12, s5, 229376
    s_add_u32 s12, s12, s15
    s_add_u32 s12, s12, 14483456
    s_mul_i32 s15, s10, 114688
    s_add_u32 s15, s15, s12
    v_lshl_add_u32 v15, v2, 4, s15
    s_mul_i32 s15, s11, 114688
    s_add_u32 s15, s15, s12
    v_lshl_add_u32 v98, v2, 4, s15
    v_lshrrev_b32 v3, 5, v2
    v_bfe_u32 v4, v2, 2, 2
    v_lshl_add_u32 v11, v3, 2, v4
    v_lshlrev_b32 v11, 7, v11
    v_bfe_u32 v12, v2, 4, 1
    v_lshl_add_u32 v11, v12, 5, v11
    v_and_b32 v12, 3, v2
    v_lshl_add_u32 v11, v12, 3, v11
    v_bfe_u32 v4, v2, 3, 1
    v_xor_b32 v12, s10, v4
    v_lshl_add_u32 v96, v12, 6, v11
    v_xor_b32 v12, s11, v4
    v_lshl_add_u32 v97, v12, 6, v11
    s_lshl_b32 s12, s48, 1
    v_add_u32 v64, s12, v96
    v_add_u32 v65, s12, v97
    s_lshl_b32 s12, s50, 1
    v_add_u32 v66, s12, v96
    v_add_u32 v67, s12, v97
    s_lshl_b32 s12, s52, 1
    v_add_u32 v68, s12, v96
    v_add_u32 v69, s12, v97
    s_lshl_b32 s12, s54, 1
    v_add_u32 v70, s12, v96
    v_add_u32 v71, s12, v97
    v_lshrrev_b32 v8, 5, v2
    s_lshl_b32 s12, s4, 7
    s_add_u32 s12, s12, 61440
    v_lshl_add_u32 v9, v8, 4, s12
    v_mov_b32 v99, 149632
    v_mov_b32 v102, 0
    v_mov_b32 v103, 0
    ds_write_b64 v99, v[102:103]
    v_and_b32 v4, 31, v2
    v_lshlrev_b32 v4, 3, v4
    s_lshl_b32 s12, s10, 8
    s_add_u32 s12, s12, 149696
    v_add_u32 v100, s12, v4
    s_lshl_b32 s12, s11, 8
    s_add_u32 s12, s12, 149696
    v_add_u32 v101, s12, v4
    s_lshl_b32 s12, s10, 11
    s_add_u32 s12, s12, 57344
    v_add_u32 v108, s12, v4
    v_add_u32 v110, s13, v96
    s_lshl_b32 s12, s11, 11
    s_add_u32 s12, s12, 57344
    v_add_u32 v109, s12, v4
    v_add_u32 v111, s13, v97
    s_mov_b32 s16, 0x3f803f80
    s_mov_b32 s20, 0
    s_mov_b32 s21, 0x7f
K3_hp:
    s_bitcmp1_b32 s21, 0
    s_cbranch_scc0 K3_hs0
    s_add_u32 s12, s13, 0
    s_mov_b32 m0, s12
    s_add_u32 s12, s14, 0
    buffer_load_dwordx4 v5, s[44:47], s12 offen sc1 lds
K3_hs0:
    s_bitcmp1_b32 s21, 1
    s_cbranch_scc0 K3_hs1
    s_add_u32 s12, s13, 8192
    s_mov_b32 m0, s12
    s_add_u32 s12, s14, 278528
    buffer_load_dwordx4 v5, s[44:47], s12 offen sc1 lds
K3_hs1:
    s_bitcmp1_b32 s21, 2
    s_cbranch_scc0 K3_hs2
    s_add_u32 s12, s13, 16384
    s_mov_b32 m0, s12
    s_add_u32 s12, s14, 557056
    buffer_load_dwordx4 v5, s[44:47], s12 offen sc1 lds
K3_hs2:
    s_bitcmp1_b32 s21, 3
    s_cbranch_scc0 K3_hs3
    s_add_u32 s12, s13, 24576
    s_mov_b32 m0, s12
    s_add_u32 s12, s14, 835584
    buffer_load_dwordx4 v5, s[44:47], s12 offen sc1 lds
K3_hs3:
    s_bitcmp1_b32 s21, 4
    s_cbranch_scc0 K3_hs4
    s_add_u32 s12, s13, 32768
    s_mov_b32 m0, s12
    s_add_u32 s12, s14, 1114112
    buffer_load_dwordx4 v5, s[44:47], s12 offen sc1 lds
K3_hs4:
    s_bitcmp1_b32 s21, 5
    s_cbranch_scc0 K3_hs5
    s_add_u32 s12, s13, 40960
    s_mov_b32 m0, s12
    s_add_u32 s12, s14, 1392640
    buffer_load_dwordx4 v5, s[44:47], s12 offen sc1 lds
K3_hs5:
    s_bitcmp1_b32 s21, 6
    s_cbranch_scc0 K3_hs6
    s_add_u32 s12, s13, 49152
    s_mov_b32 m0, s12
    s_add_u32 s12, s14, 1671168
    buffer_load_dwordx4 v5, s[44:47], s12 offen sc1 lds
K3_hs6:
    s_add_u32 s20, s20, 1
    s_mov_b32 s21, 0
    s_waitcnt vmcnt(0)
    ds_read_b32 v16, v6 offset:0
    ds_read_b32 v17, v6 offset:8192
    ds_read_b32 v18, v6 offset:16384
    ds_read_b32 v19, v6 offset:24576
    ds_read_b32 v20, v6 offset:32768
    ds_read_b32 v21, v6 offset:40960
    ds_read_b32 v22, v6 offset:49152
    s_waitcnt lgkmcnt(6)
    v_cmp_eq_u32 vcc, -1, v16
    s_nop 0
    s_cmp_lg_u64 vcc, 0
    s_cselect_b32 s12, 1, 0
    s_or_b32 s21, s21, s12
    s_waitcnt lgkmcnt(5)
    v_cmp_eq_u32 vcc, -1, v17
    s_nop 0
    s_cmp_lg_u64 vcc, 0
    s_cselect_b32 s12, 2, 0
    s_or_b32 s21, s21, s12
    s_waitcnt lgkmcnt(4)
    v_cmp_eq_u32 vcc, -1, v18
    s_nop 0
    s_cmp_lg_u64 vcc, 0
    s_cselect_b32 s12, 4, 0
    s_or_b32 s21, s21, s12
    s_waitcnt lgkmcnt(3)
    v_cmp_eq_u32 vcc, -1, v19
    s_nop 0
    s_cmp_lg_u64 vcc, 0
    s_cselect_b32 s12, 8, 0
    s_or_b32 s21, s21, s12
    s_waitcnt lgkmcnt(2)
    v_cmp_eq_u32 vcc, -1, v20
    s_nop 0
    s_cmp_lg_u64 vcc, 0
    s_cselect_b32 s12, 16, 0
    s_or_b32 s21, s21, s12
    s_waitcnt lgkmcnt(1)
    v_cmp_eq_u32 vcc, -1, v21
    s_nop 0
    s_cmp_lg_u64 vcc, 0
    s_cselect_b32 s12, 32, 0
    s_or_b32 s21, s21, s12
    s_waitcnt lgkmcnt(0)
    v_cmp_eq_u32 vcc, -1, v22
    s_nop 0
    s_cmp_lg_u64 vcc, 0
    s_cselect_b32 s12, 64, 0
    s_or_b32 s21, s21, s12
    s_cmp_gt_u32 s20, 200000
    s_cbranch_scc1 K3_hok
    s_cmp_lg_u32 s21, 0
    s_cbranch_scc1 K3_hp
K3_hok:
    s_mov_b32 s31, s20
    s_lshl_b32 s12, s5, 7
    s_add_u32 s12, s12, 21823488
    v_mov_b32 v6, s12
    global_load_dword v5, v6, s[40:41] sc1
    ds_read_b64_tr_b16 v[16:17], v110 offset:0
    ds_read_b64_tr_b16 v[18:19], v111 offset:0
    ds_read_b64_tr_b16 v[20:21], v110 offset:8192
    ds_read_b64_tr_b16 v[22:23], v111 offset:8192
    ds_read_b64_tr_b16 v[24:25], v110 offset:16384
    ds_read_b64_tr_b16 v[26:27], v111 offset:16384
    ds_read_b64_tr_b16 v[28:29], v110 offset:24576
    ds_read_b64_tr_b16 v[30:31], v111 offset:24576
    ds_read_b64_tr_b16 v[32:33], v110 offset:32768
    ds_read_b64_tr_b16 v[34:35], v111 offset:32768
    ds_read_b64_tr_b16 v[36:37], v110 offset:40960
    ds_read_b64_tr_b16 v[38:39], v111 offset:40960
    ds_read_b64_tr_b16 v[40:41], v110 offset:49152
    ds_read_b64_tr_b16 v[42:43], v111 offset:49152
    s_lshl_b32 s12, s4, 8
    v_add_u32 v110, s12, v108
    v_add_u32 v111, s12, v109
    s_waitcnt lgkmcnt(13)
    v_dot2_f32_bf16 v48, v16, s16, 0
    v_dot2_f32_bf16 v49, v16, v16, 0
    v_dot2_f32_bf16 v50, v17, s16, 0
    v_dot2_f32_bf16 v51, v17, v17, 0
    s_waitcnt lgkmcnt(12)
    v_dot2_f32_bf16 v52, v18, s16, 0
    v_dot2_f32_bf16 v53, v18, v18, 0
    v_dot2_f32_bf16 v54, v19, s16, 0
    v_dot2_f32_bf16 v55, v19, v19, 0
    s_waitcnt lgkmcnt(11)
    v_dot2_f32_bf16 v48, v20, s16, v48
    v_dot2_f32_bf16 v49, v20, v20, v49
    v_dot2_f32_bf16 v50, v21, s16, v50
    v_dot2_f32_bf16 v51, v21, v21, v51
    s_waitcnt lgkmcnt(10)
    v_dot2_f32_bf16 v52, v22, s16, v52
    v_dot2_f32_bf16 v53, v22, v22, v53
    v_dot2_f32_bf16 v54, v23, s16, v54
    v_dot2_f32_bf16 v55, v23, v23, v55
    s_waitcnt lgkmcnt(9)
    v_dot2_f32_bf16 v48, v24, s16, v48
    v_dot2_f32_bf16 v49, v24, v24, v49
    v_dot2_f32_bf16 v50, v25, s16, v50
    v_dot2_f32_bf16 v51, v25, v25, v51
    s_waitcnt lgkmcnt(8)
    v_dot2_f32_bf16 v52, v26, s16, v52
    v_dot2_f32_bf16 v53, v26, v26, v53
    v_dot2_f32_bf16 v54, v27, s16, v54
    v_dot2_f32_bf16 v55, v27, v27, v55
    s_waitcnt lgkmcnt(7)
    v_dot2_f32_bf16 v48, v28, s16, v48
    v_dot2_f32_bf16 v49, v28, v28, v49
    v_dot2_f32_bf16 v50, v29, s16, v50
    v_dot2_f32_bf16 v51, v29, v29, v51
    s_waitcnt lgkmcnt(6)
    v_dot2_f32_bf16 v52, v30, s16, v52
    v_dot2_f32_bf16 v53, v30, v30, v53
    v_dot2_f32_bf16 v54, v31, s16, v54
    v_dot2_f32_bf16 v55, v31, v31, v55
    s_waitcnt lgkmcnt(5)
    v_dot2_f32_bf16 v48, v32, s16, v48
    v_dot2_f32_bf16 v49, v32, v32, v49
    v_dot2_f32_bf16 v50, v33, s16, v50
    v_dot2_f32_bf16 v51, v33, v33, v51
    s_waitcnt lgkmcnt(4)
    v_dot2_f32_bf16 v52, v34, s16, v52
    v_dot2_f32_bf16 v53, v34, v34, v53
    v_dot2_f32_bf16 v54, v35, s16, v54
    v_dot2_f32_bf16 v55, v35, v35, v55
    s_waitcnt lgkmcnt(3)
    v_dot2_f32_bf16 v48, v36, s16, v48
    v_dot2_f32_bf16 v49, v36, v36, v49
    v_dot2_f32_bf16 v50, v37, s16, v50
    v_dot2_f32_bf16 v51, v37, v37, v51
    s_waitcnt lgkmcnt(2)
    v_dot2_f32_bf16 v52, v38, s16, v52
    v_dot2_f32_bf16 v53, v38, v38, v53
    v_dot2_f32_bf16 v54, v39, s16, v54
    v_dot2_f32_bf16 v55, v39, v39, v55
    s_waitcnt lgkmcnt(1)
    v_dot2_f32_bf16 v48, v40, s16, v48
    v_dot2_f32_bf16 v49, v40, v40, v49
    v_dot2_f32_bf16 v50, v41, s16, v50
    v_dot2_f32_bf16 v51, v41, v41, v51
    s_waitcnt lgkmcnt(0)
    v_dot2_f32_bf16 v52, v42, s16, v52
    v_dot2_f32_bf16 v53, v42, v42, v53
    v_dot2_f32_bf16 v54, v43, s16, v54
    v_dot2_f32_bf16 v55, v43, v43, v55
    s_nop 3
    v_add_f32 v48, v48, v50
    v_add_f32 v49, v49, v51
    v_add_f32 v52, v52, v54
    v_add_f32 v53, v53, v55
    v_mov_b32 v50, v48
    v_mov_b32 v51, v49
    v_mov_b32 v54, v52
    v_mov_b32 v55, v53
    v_permlane32_swap_b32 v48, v50
    v_permlane32_swap_b32 v49, v51
    v_permlane32_swap_b32 v52, v54
    v_permlane32_swap_b32 v53, v55
    v_add_f32 v48, v48, v50
    v_add_f32 v49, v49, v51
    v_add_f32 v52, v52, v54
    v_add_f32 v53, v53, v55
    ds_write_b64 v110, v[48:49]
    ds_write_b64 v111, v[52:53]
    s_waitcnt lgkmcnt(0)
    s_barrier
    s_setprio 3
    s_cmp_lt_u32 s4, 4
    s_cbranch_scc1 K3_loop
    s_cmp_ge_u32 s4, 6
    s_cbranch_scc1 K3_g1b
    ds_read2_b64 v[16:19], v108 offset0:0 offset1:32
    ds_read2_b64 v[20:23], v108 offset0:64 offset1:96
    ds_read2_b64 v[24:27], v108 offset0:128 offset1:160
    ds_read2_b64 v[28:31], v108 offset0:192 offset1:224
    s_waitcnt lgkmcnt(0)
    v_add_f32 v16, v16, v18
    v_add_f32 v17, v17, v19
    v_add_f32 v20, v20, v22
    v_add_f32 v21, v21, v23
    v_add_f32 v24, v24, v26
    v_add_f32 v25, v25, v27
    v_add_f32 v28, v28, v30
    v_add_f32 v29, v29, v31
    v_add_f32 v16, v16, v20
    v_add_f32 v17, v17, v21
    v_add_f32 v24, v24, v28
    v_add_f32 v25, v25, v29
    v_add_f32 v16, v16, v24
    v_add_f32 v17, v17, v25
    v_mul_f32 v16, 0x3b124925, v16
    v_mul_f32 v17, 0x3b124925, v17
    v_fma_f32 v17, -v16, v16, v17
    v_max_f32 v17, 0, v17
    v_cvt_pk_bf16_f32 v18, v17, -v16
    v_and_b32 v20, 0xffff0000, v18
    v_lshlrev_b32 v18, 16, v18
    v_add_f32 v18, 0x3727c5ac, v18
    v_cvt_pk_bf16_f32 v18, v18, v18
    v_lshlrev_b32 v18, 16, v18
    v_sqrt_f32 v18, v18
    s_nop 0
    v_cvt_pk_bf16_f32 v18, v18, v18
    v_lshlrev_b32 v18, 16, v18
    v_rcp_f32 v21, v18
    v_mov_b32 v4, 1
    v_cmp_eq_u32 vcc, 0, v2
    ds_write_b64 v100, v[20:21]
    s_and_saveexec_b64 s[12:13], vcc
    ds_add_u32 v99, v4
    s_mov_b64 exec, s[12:13]
    s_branch K3_g1c
K3_g1b:
    v_subrev_u32 v10, 384, v0
    v_lshrrev_b32 v3, 3, v10
    v_and_b32 v4, 7, v10
    v_lshrrev_b32 v7, 2, v4
    v_lshrrev_b32 v8, 1, v3
    v_xor_b32 v7, v7, v8
    v_and_b32 v7, 1, v7
    v_lshlrev_b32 v8, 7, v3
    v_lshl_add_u32 v8, v7, 6, v8
    v_and_b32 v7, 3, v4
    v_lshl_add_u32 v8, v7, 4, v8
    s_lshl_b32 s12, s6, 13
    v_add_u32 v8, s12, v8
    v_lshrrev_b32 v7, 3, v3
    v_mul_u32_u24 v7, 1040, v7
    v_and_b32 v10, 7, v3
    v_lshl_add_u32 v7, v10, 7, v7
    v_lshl_add_u32 v7, v4, 4, v7
    v_add_u32 v7, 141312, v7
    ds_read_b128 v[16:19], v8 offset:0
    ds_read_b128 v[20:23], v8 offset:2048
    ds_read_b128 v[24:27], v8 offset:4096
    ds_read_b128 v[28:31], v8 offset:6144
    s_waitcnt lgkmcnt(0)
    ds_write_b128 v7, v[16:19] offset:0
    ds_write_b128 v7, v[20:23] offset:2080
    ds_write_b128 v7, v[24:27] offset:4160
    ds_write_b128 v7, v[28:31] offset:6240
K3_g1c:
    s_waitcnt lgkmcnt(0)
    s_setprio 1
K3_loop:
    ds_read_b64_tr_b16 v[112:113], v64 offset:0
    ds_read_b64_tr_b16 v[114:115], v64 offset:1024
    ds_read_b64_tr_b16 v[116:117], v65 offset:0
    ds_read_b64_tr_b16 v[118:119], v65 offset:1024
    ds_read_b64_tr_b16 v[120:121], v64 offset:2048
    ds_read_b64_tr_b16 v[122:123], v64 offset:3072
    ds_read_b64_tr_b16 v[124:125], v65 offset:2048
    ds_read_b64_tr_b16 v[126:127], v65 offset:3072
    ds_read_b64_tr_b16 v[128:129], v64 offset:4096
    ds_read_b64_tr_b16 v[130:131], v64 offset:5120
    ds_read_b64_tr_b16 v[132:133], v65 offset:4096
    ds_read_b64_tr_b16 v[134:135], v65 offset:5120
    s_waitcnt lgkmcnt(10)
    v_mfma_f32_32x32x16_bf16 v[16:31], v[144:147], v[112:115], 0
    s_waitcnt lgkmcnt(8)
    v_mfma_f32_32x32x16_bf16 v[32:47], v[144:147], v[116:119], 0
    ds_read_b64_tr_b16 v[136:137], v64 offset:6144
    ds_read_b64_tr_b16 v[138:139], v64 offset:7168
    ds_read_b64_tr_b16 v[140:141], v65 offset:6144
    ds_read_b64_tr_b16 v[142:143], v65 offset:7168
    s_waitcnt lgkmcnt(10)
    v_mfma_f32_32x32x16_bf16 v[16:31], v[148:151], v[120:123], v[16:31]
    s_waitcnt lgkmcnt(8)
    v_mfma_f32_32x32x16_bf16 v[32:47], v[148:151], v[124:127], v[32:47]
    buffer_load_dwordx4 v[144:147], v13, s[44:47], s62 offen offset:0
    ds_read_b64_tr_b16 v[112:113], v64 offset:8192
    ds_read_b64_tr_b16 v[114:115], v64 offset:9216
    ds_read_b64_tr_b16 v[116:117], v65 offset:8192
    ds_read_b64_tr_b16 v[118:119], v65 offset:9216
    s_waitcnt lgkmcnt(10)
    v_mfma_f32_32x32x16_bf16 v[16:31], v[152:155], v[128:131], v[16:31]
    s_waitcnt lgkmcnt(8)
    v_mfma_f32_32x32x16_bf16 v[32:47], v[152:155], v[132:135], v[32:47]
    buffer_load_dwordx4 v[148:151], v14, s[44:47], s62 offen offset:0
    ds_read_b64_tr_b16 v[120:121], v64 offset:10240
    ds_read_b64_tr_b16 v[122:123], v64 offset:11264
    ds_read_b64_tr_b16 v[124:125], v65 offset:10240
    ds_read_b64_tr_b16 v[126:127], v65 offset:11264
    s_waitcnt lgkmcnt(10)
    v_mfma_f32_32x32x16_bf16 v[16:31], v[156:159], v[136:139], v[16:31]
    s_waitcnt lgkmcnt(8)
    v_mfma_f32_32x32x16_bf16 v[32:47], v[156:159], v[140:143], v[32:47]
    buffer_load_dwordx4 v[152:155], v13, s[44:47], s62 offen offset:1024
    ds_read_b64_tr_b16 v[128:129], v64 offset:12288
    ds_read_b64_tr_b16 v[130:131], v64 offset:13312
    ds_read_b64_tr_b16 v[132:133], v65 offset:12288
    ds_read_b64_tr_b16 v[134:135], v65 offset:13312
    s_waitcnt lgkmcnt(10)
    v_mfma_f32_32x32x16_bf16 v[16:31], v[160:163], v[112:115], v[16:31]
    s_waitcnt lgkmcnt(8)
    v_mfma_f32_32x32x16_bf16 v[32:47], v[160:163], v[116:119], v[32:47]
    buffer_load_dwordx4 v[156:159], v14, s[44:47], s62 offen offset:1024
    ds_read_b64_tr_b16 v[136:137], v66 offset:0
    ds_read_b64_tr_b16 v[138:139], v66 offset:1024
    ds_read_b64_tr_b16 v[140:141], v67 offset:0
    ds_read_b64_tr_b16 v[142:143], v67 offset:1024
    s_waitcnt lgkmcnt(10)
    v_mfma_f32_32x32x16_bf16 v[16:31], v[164:167], v[120:123], v[16:31]
    s_waitcnt lgkmcnt(8)
    v_mfma_f32_32x32x16_bf16 v[32:47], v[164:167], v[124:127], v[32:47]
    buffer_load_dwordx4 v[160:163], v13, s[44:47], s56 offen offset:0
    ds_read_b64_tr_b16 v[112:113], v66 offset:2048
    ds_read_b64_tr_b16 v[114:115], v66 offset:3072
    ds_read_b64_tr_b16 v[116:117], v67 offset:2048
    ds_read_b64_tr_b16 v[118:119], v67 offset:3072
    s_waitcnt lgkmcnt(10)
    v_mfma_f32_32x32x16_bf16 v[16:31], v[168:171], v[128:131], v[16:31]
    s_waitcnt lgkmcnt(8)
    v_mfma_f32_32x32x16_bf16 v[32:47], v[168:171], v[132:135], v[32:47]
    buffer_load_dwordx4 v[164:167], v14, s[44:47], s56 offen offset:0
    ds_read_b64_tr_b16 v[120:121], v66 offset:4096
    ds_read_b64_tr_b16 v[122:123], v66 offset:5120
    ds_read_b64_tr_b16 v[124:125], v67 offset:4096
    ds_read_b64_tr_b16 v[126:127], v67 offset:5120
    s_waitcnt lgkmcnt(10)
    v_mfma_f32_32x32x16_bf16 v[16:31], v[172:175], v[136:139], v[16:31]
    s_waitcnt lgkmcnt(8)
    v_mfma_f32_32x32x16_bf16 v[32:47], v[172:175], v[140:143], v[32:47]
    buffer_load_dwordx4 v[168:171], v13, s[44:47], s56 offen offset:1024
    ds_read_b64_tr_b16 v[128:129], v66 offset:6144
    ds_read_b64_tr_b16 v[130:131], v66 offset:7168
    ds_read_b64_tr_b16 v[132:133], v67 offset:6144
    ds_read_b64_tr_b16 v[134:135], v67 offset:7168
    s_waitcnt lgkmcnt(10)
    v_mfma_f32_32x32x16_bf16 v[16:31], v[176:179], v[112:115], v[16:31]
    s_waitcnt lgkmcnt(8)
    v_mfma_f32_32x32x16_bf16 v[32:47], v[176:179], v[116:119], v[32:47]
    buffer_load_dwordx4 v[172:175], v14, s[44:47], s56 offen offset:1024
    ds_read_b64_tr_b16 v[136:137], v66 offset:8192
    ds_read_b64_tr_b16 v[138:139], v66 offset:9216
    ds_read_b64_tr_b16 v[140:141], v67 offset:8192
    ds_read_b64_tr_b16 v[142:143], v67 offset:9216
    s_waitcnt lgkmcnt(10)
    v_mfma_f32_32x32x16_bf16 v[16:31], v[180:183], v[120:123], v[16:31]
    s_waitcnt lgkmcnt(8)
    v_mfma_f32_32x32x16_bf16 v[32:47], v[180:183], v[124:127], v[32:47]
    buffer_load_dwordx4 v[176:179], v13, s[44:47], s57 offen offset:0
    ds_read_b64_tr_b16 v[112:113], v66 offset:10240
    ds_read_b64_tr_b16 v[114:115], v66 offset:11264
    ds_read_b64_tr_b16 v[116:117], v67 offset:10240
    ds_read_b64_tr_b16 v[118:119], v67 offset:11264
    s_waitcnt lgkmcnt(10)
    v_mfma_f32_32x32x16_bf16 v[16:31], v[184:187], v[128:131], v[16:31]
    s_waitcnt lgkmcnt(8)
    v_mfma_f32_32x32x16_bf16 v[32:47], v[184:187], v[132:135], v[32:47]
    buffer_load_dwordx4 v[180:183], v14, s[44:47], s57 offen offset:0
    ds_read_b64_tr_b16 v[120:121], v66 offset:12288
    ds_read_b64_tr_b16 v[122:123], v66 offset:13312
    ds_read_b64_tr_b16 v[124:125], v67 offset:12288
    ds_read_b64_tr_b16 v[126:127], v67 offset:13312
    s_waitcnt lgkmcnt(10)
    v_mfma_f32_32x32x16_bf16 v[16:31], v[188:191], v[136:139], v[16:31]
    s_waitcnt lgkmcnt(8)
    v_mfma_f32_32x32x16_bf16 v[32:47], v[188:191], v[140:143], v[32:47]
    buffer_load_dwordx4 v[184:187], v13, s[44:47], s57 offen offset:1024
    ds_read_b64_tr_b16 v[128:129], v68 offset:0
    ds_read_b64_tr_b16 v[130:131], v68 offset:1024
    ds_read_b64_tr_b16 v[132:133], v69 offset:0
    ds_read_b64_tr_b16 v[134:135], v69 offset:1024
    s_waitcnt lgkmcnt(10)
    v_mfma_f32_32x32x16_bf16 v[16:31], v[192:195], v[112:115], v[16:31]
    s_waitcnt lgkmcnt(8)
    v_mfma_f32_32x32x16_bf16 v[32:47], v[192:195], v[116:119], v[32:47]
    buffer_load_dwordx4 v[188:191], v14, s[44:47], s57 offen offset:1024
    ds_read_b64_tr_b16 v[136:137], v68 offset:2048
    ds_read_b64_tr_b16 v[138:139], v68 offset:3072
    ds_read_b64_tr_b16 v[140:141], v69 offset:2048
    ds_read_b64_tr_b16 v[142:143], v69 offset:3072
    ds_read_b128 v[72:75], v9 offset:0
    ds_read_b128 v[48:51], v9 offset:1024
    ds_read_b128 v[76:79], v9 offset:32
    ds_read_b128 v[52:55], v9 offset:1056
    ds_read_b128 v[80:83], v9 offset:64
    ds_read_b128 v[56:59], v9 offset:1088
    ds_read_b128 v[84:87], v9 offset:96
    ds_read_b128 v[60:63], v9 offset:1120
    s_waitcnt lgkmcnt(15)
    v_mfma_f32_32x32x16_bf16 v[16:31], v[196:199], v[120:123], v[16:31]
    s_waitcnt lgkmcnt(15)
    v_mfma_f32_32x32x16_bf16 v[32:47], v[196:199], v[124:127], v[32:47]
    buffer_load_dwordx4 v[192:195], v13, s[44:47], s58 offen offset:0
    ds_read_b64_tr_b16 v[112:113], v68 offset:4096
    ds_read_b64_tr_b16 v[114:115], v68 offset:5120
    ds_read_b64_tr_b16 v[116:117], v69 offset:4096
    ds_read_b64_tr_b16 v[118:119], v69 offset:5120
    s_waitcnt lgkmcnt(15)
    v_mfma_f32_32x32x16_bf16 v[16:31], v[200:203], v[128:131], v[16:31]
    s_waitcnt lgkmcnt(15)
    v_mfma_f32_32x32x16_bf16 v[32:47], v[200:203], v[132:135], v[32:47]
    buffer_load_dwordx4 v[196:199], v14, s[44:47], s58 offen offset:0
    ds_read_b64_tr_b16 v[120:121], v68 offset:6144
    ds_read_b64_tr_b16 v[122:123], v68 offset:7168
    ds_read_b64_tr_b16 v[124:125], v69 offset:6144
    ds_read_b64_tr_b16 v[126:127], v69 offset:7168
    s_waitcnt lgkmcnt(15)
    v_mfma_f32_32x32x16_bf16 v[16:31], v[204:207], v[136:139], v[16:31]
    s_waitcnt lgkmcnt(15)
    v_mfma_f32_32x32x16_bf16 v[32:47], v[204:207], v[140:143], v[32:47]
    buffer_load_dwordx4 v[200:203], v13, s[44:47], s58 offen offset:1024
    ds_read_b64_tr_b16 v[128:129], v68 offset:8192
    ds_read_b64_tr_b16 v[130:131], v68 offset:9216
    ds_read_b64_tr_b16 v[132:133], v69 offset:8192
    ds_read_b64_tr_b16 v[134:135], v69 offset:9216
    s_waitcnt lgkmcnt(10)
    v_mfma_f32_32x32x16_bf16 v[16:31], v[208:211], v[112:115], v[16:31]
    s_waitcnt lgkmcnt(8)
    v_mfma_f32_32x32x16_bf16 v[32:47], v[208:211], v[116:119], v[32:47]
    buffer_load_dwordx4 v[204:207], v14, s[44:47], s58 offen offset:1024
    ds_read_b64_tr_b16 v[136:137], v68 offset:10240
    ds_read_b64_tr_b16 v[138:139], v68 offset:11264
    ds_read_b64_tr_b16 v[140:141], v69 offset:10240
    ds_read_b64_tr_b16 v[142:143], v69 offset:11264
    s_waitcnt lgkmcnt(10)
    v_mfma_f32_32x32x16_bf16 v[16:31], v[212:215], v[120:123], v[16:31]
    s_waitcnt lgkmcnt(8)
    v_mfma_f32_32x32x16_bf16 v[32:47], v[212:215], v[124:127], v[32:47]
    buffer_load_dwordx4 v[208:211], v13, s[44:47], s59 offen offset:0
    ds_read_b64_tr_b16 v[112:113], v68 offset:12288
    ds_read_b64_tr_b16 v[114:115], v68 offset:13312
    ds_read_b64_tr_b16 v[116:117], v69 offset:12288
    ds_read_b64_tr_b16 v[118:119], v69 offset:13312
    s_waitcnt lgkmcnt(10)
    v_mfma_f32_32x32x16_bf16 v[16:31], v[216:219], v[128:131], v[16:31]
    s_waitcnt lgkmcnt(8)
    v_mfma_f32_32x32x16_bf16 v[32:47], v[216:219], v[132:135], v[32:47]
    buffer_load_dwordx4 v[212:215], v14, s[44:47], s59 offen offset:0
    ds_read_b64_tr_b16 v[120:121], v70 offset:0
    ds_read_b64_tr_b16 v[122:123], v70 offset:1024
    ds_read_b64_tr_b16 v[124:125], v71 offset:0
    ds_read_b64_tr_b16 v[126:127], v71 offset:1024
    s_waitcnt lgkmcnt(10)
    v_mfma_f32_32x32x16_bf16 v[16:31], v[220:223], v[136:139], v[16:31]
    s_waitcnt lgkmcnt(8)
    v_mfma_f32_32x32x16_bf16 v[32:47], v[220:223], v[140:143], v[32:47]
    buffer_load_dwordx4 v[216:219], v13, s[44:47], s59 offen offset:1024
    ds_read_b64_tr_b16 v[128:129], v70 offset:2048
    ds_read_b64_tr_b16 v[130:131], v70 offset:3072
    ds_read_b64_tr_b16 v[132:133], v71 offset:2048
    ds_read_b64_tr_b16 v[134:135], v71 offset:3072
    s_waitcnt lgkmcnt(10)
    v_mfma_f32_32x32x16_bf16 v[16:31], v[224:227], v[112:115], v[16:31]
    s_waitcnt lgkmcnt(8)
    v_mfma_f32_32x32x16_bf16 v[32:47], v[224:227], v[116:119], v[32:47]
    buffer_load_dwordx4 v[220:223], v14, s[44:47], s59 offen offset:1024
    ds_read_b64_tr_b16 v[136:137], v70 offset:4096
    ds_read_b64_tr_b16 v[138:139], v70 offset:5120
    ds_read_b64_tr_b16 v[140:141], v71 offset:4096
    ds_read_b64_tr_b16 v[142:143], v71 offset:5120
    s_waitcnt lgkmcnt(10)
    v_mfma_f32_32x32x16_bf16 v[16:31], v[228:231], v[120:123], v[16:31]
    s_waitcnt lgkmcnt(8)
    v_mfma_f32_32x32x16_bf16 v[32:47], v[228:231], v[124:127], v[32:47]
    buffer_load_dwordx4 v[224:227], v13, s[44:47], s60 offen offset:0
    ds_read_b64_tr_b16 v[112:113], v70 offset:6144
    ds_read_b64_tr_b16 v[114:115], v70 offset:7168
    ds_read_b64_tr_b16 v[116:117], v71 offset:6144
    ds_read_b64_tr_b16 v[118:119], v71 offset:7168
    s_waitcnt lgkmcnt(10)
    v_mfma_f32_32x32x16_bf16 v[16:31], v[232:235], v[128:131], v[16:31]
    s_waitcnt lgkmcnt(8)
    v_mfma_f32_32x32x16_bf16 v[32:47], v[232:235], v[132:135], v[32:47]
    buffer_load_dwordx4 v[228:231], v14, s[44:47], s60 offen offset:0
    ds_read_b64_tr_b16 v[120:121], v70 offset:8192
    ds_read_b64_tr_b16 v[122:123], v70 offset:9216
    ds_read_b64_tr_b16 v[124:125], v71 offset:8192
    ds_read_b64_tr_b16 v[126:127], v71 offset:9216
    s_waitcnt lgkmcnt(10)
    v_mfma_f32_32x32x16_bf16 v[16:31], v[236:239], v[136:139], v[16:31]
    s_waitcnt lgkmcnt(8)
    v_mfma_f32_32x32x16_bf16 v[32:47], v[236:239], v[140:143], v[32:47]
    buffer_load_dwordx4 v[232:235], v13, s[44:47], s60 offen offset:1024
    ds_read_b64_tr_b16 v[128:129], v70 offset:10240
    ds_read_b64_tr_b16 v[130:131], v70 offset:11264
    ds_read_b64_tr_b16 v[132:133], v71 offset:10240
    ds_read_b64_tr_b16 v[134:135], v71 offset:11264
    s_waitcnt lgkmcnt(10)
    v_mfma_f32_32x32x16_bf16 v[16:31], v[240:243], v[112:115], v[16:31]
    s_waitcnt lgkmcnt(8)
    v_mfma_f32_32x32x16_bf16 v[32:47], v[240:243], v[116:119], v[32:47]
    buffer_load_dwordx4 v[236:239], v14, s[44:47], s60 offen offset:1024
    ds_read_b64_tr_b16 v[136:137], v70 offset:12288
    ds_read_b64_tr_b16 v[138:139], v70 offset:13312
    ds_read_b64_tr_b16 v[140:141], v71 offset:12288
    ds_read_b64_tr_b16 v[142:143], v71 offset:13312
    s_waitcnt lgkmcnt(10)
    v_mfma_f32_32x32x16_bf16 v[16:31], v[244:247], v[120:123], v[16:31]
    s_waitcnt lgkmcnt(8)
    v_mfma_f32_32x32x16_bf16 v[32:47], v[244:247], v[124:127], v[32:47]
    buffer_load_dwordx4 v[240:243], v13, s[44:47], s61 offen offset:0
    ds_read_b32 v3, v99
    ds_read_b64 v[104:105], v100
    ds_read_b64 v[106:107], v101
    s_waitcnt lgkmcnt(9)
    v_mfma_f32_32x32x16_bf16 v[16:31], v[248:251], v[128:131], v[16:31]
    s_waitcnt lgkmcnt(7)
    v_mfma_f32_32x32x16_bf16 v[32:47], v[248:251], v[132:135], v[32:47]
    buffer_load_dwordx4 v[244:247], v14, s[44:47], s61 offen offset:0
    s_waitcnt lgkmcnt(5)
    v_mfma_f32_32x32x16_bf16 v[16:31], v[252:255], v[136:139], v[16:31]
    s_waitcnt lgkmcnt(3)
    v_mfma_f32_32x32x16_bf16 v[32:47], v[252:255], v[140:143], v[32:47]
    buffer_load_dwordx4 v[248:251], v13, s[44:47], s61 offen offset:1024
    buffer_load_dwordx4 v[252:255], v14, s[44:47], s61 offen offset:1024
    s_setprio 3
    s_waitcnt lgkmcnt(0)
    v_readfirstlane_b32 s12, v3
    s_nop 0
    s_cmp_ge_u32 s12, 2
    s_cbranch_scc1 K3_sok
K3_sw:
    ds_read_b32 v3, v99
    ds_read_b64 v[104:105], v100
    ds_read_b64 v[106:107], v101
    s_waitcnt lgkmcnt(0)
    v_readfirstlane_b32 s12, v3
    s_nop 0
    s_cmp_lt_u32 s12, 2
    s_cbranch_scc1 K3_sw
K3_sok:
    s_waitcnt vmcnt(28)
    v_cmp_eq_u32 vcc, 0, v5
    s_cbranch_vccnz K3_fw
K3_fok:
    v_mov_b32 v4, 1
    v_cmp_eq_u32 vcc, 0, v2
    s_nop 0
    s_and_saveexec_b64 s[12:13], vcc
    ds_add_u32 v99, v4 offset:4
    s_mov_b64 exec, s[12:13]
    v_lshlrev_b32 v3, 4, v2
    s_lshl_b32 s13, s5, 1
    s_add_u32 s12, s10, s13
    s_mul_i32 s12, s12, 112
    s_lshl_b32 s13, s9, 1
    s_add_u32 s12, s12, s13
    s_lshl_b32 s12, s12, 10
    s_add_u32 s12, s12, 14483456
    v_add_u32 v96, s12, v3
    s_lshl_b32 s13, s5, 1
    s_add_u32 s12, s11, s13
    s_mul_i32 s12, s12, 112
    s_lshl_b32 s13, s9, 1
    s_add_u32 s12, s12, s13
    s_lshl_b32 s12, s12, 10
    s_add_u32 s12, s12, 14483456
    v_add_u32 v97, s12, v3
    s_mov_b32 s16, 0x00003f80
    s_mov_b32 s17, 0x3f800000
    v_mov_b32 v108, 0xc0135761
    v_mov_b32 v109, 0xbdd2d3e8
    v_mov_b32 v110, 1.0
    v_mov_b32 v111, 1.0
    v_fma_f32 v16, v72, v104, v16
    v_fma_f32 v17, v73, v104, v17
    v_fma_f32 v18, v74, v104, v18
    v_fma_f32 v19, v75, v104, v19
    v_fma_f32 v20, v76, v104, v20
    v_fma_f32 v21, v77, v104, v21
    v_fma_f32 v22, v78, v104, v22
    v_fma_f32 v23, v79, v104, v23
    v_fma_f32 v24, v80, v104, v24
    v_fma_f32 v25, v81, v104, v25
    v_fma_f32 v26, v82, v104, v26
    v_fma_f32 v27, v83, v104, v27
    v_fma_f32 v28, v84, v104, v28
    v_fma_f32 v29, v85, v104, v29
    v_fma_f32 v30, v86, v104, v30
    v_fma_f32 v31, v87, v104, v31
    v_mul_f32 v16, v16, v105
    v_mul_f32 v17, v17, v105
    v_mul_f32 v18, v18, v105
    v_mul_f32 v19, v19, v105
    v_mul_f32 v20, v20, v105
    v_mul_f32 v21, v21, v105
    v_mul_f32 v22, v22, v105
    v_mul_f32 v23, v23, v105
    v_mul_f32 v24, v24, v105
    v_mul_f32 v25, v25, v105
    v_mul_f32 v26, v26, v105
    v_mul_f32 v27, v27, v105
    v_mul_f32 v28, v28, v105
    v_mul_f32 v29, v29, v105
    v_mul_f32 v30, v30, v105
    v_mul_f32 v31, v31, v105
    v_cvt_pk_bf16_f32 v16, 0, v16
    v_cvt_pk_bf16_f32 v17, 0, v17
    v_cvt_pk_bf16_f32 v18, 0, v18
    v_cvt_pk_bf16_f32 v19, 0, v19
    v_cvt_pk_bf16_f32 v20, 0, v20
    v_cvt_pk_bf16_f32 v21, 0, v21
    v_cvt_pk_bf16_f32 v22, 0, v22
    v_cvt_pk_bf16_f32 v23, 0, v23
    v_cvt_pk_bf16_f32 v24, 0, v24
    v_cvt_pk_bf16_f32 v25, 0, v25
    v_cvt_pk_bf16_f32 v26, 0, v26
    v_cvt_pk_bf16_f32 v27, 0, v27
    v_cvt_pk_bf16_f32 v28, 0, v28
    v_cvt_pk_bf16_f32 v29, 0, v29
    v_cvt_pk_bf16_f32 v30, 0, v30
    v_cvt_pk_bf16_f32 v31, 0, v31
    v_add_f32 v16, v16, v48
    v_add_f32 v17, v17, v49
    v_add_f32 v18, v18, v50
    v_add_f32 v19, v19, v51
    v_add_f32 v20, v20, v52
    v_add_f32 v21, v21, v53
    v_add_f32 v22, v22, v54
    v_add_f32 v23, v23, v55
    v_add_f32 v24, v24, v56
    v_add_f32 v25, v25, v57
    v_add_f32 v26, v26, v58
    v_add_f32 v27, v27, v59
    v_add_f32 v28, v28, v60
    v_add_f32 v29, v29, v61
    v_add_f32 v30, v30, v62
    v_add_f32 v31, v31, v63
    v_cvt_pk_bf16_f32 v16, 0, v16
    v_cvt_pk_bf16_f32 v17, 0, v17
    v_cvt_pk_bf16_f32 v18, 0, v18
    v_cvt_pk_bf16_f32 v19, 0, v19
    v_cvt_pk_bf16_f32 v20, 0, v20
    v_cvt_pk_bf16_f32 v21, 0, v21
    v_cvt_pk_bf16_f32 v22, 0, v22
    v_cvt_pk_bf16_f32 v23, 0, v23
    v_cvt_pk_bf16_f32 v24, 0, v24
    v_cvt_pk_bf16_f32 v25, 0, v25
    v_cvt_pk_bf16_f32 v26, 0, v26
    v_cvt_pk_bf16_f32 v27, 0, v27
    v_cvt_pk_bf16_f32 v28, 0, v28
    v_cvt_pk_bf16_f32 v29, 0, v29
    v_cvt_pk_bf16_f32 v30, 0, v30
    v_cvt_pk_bf16_f32 v31, 0, v31
    v_mul_f32 v112, v16, v16
    v_mul_f32 v113, v17, v17
    v_mul_f32 v114, v18, v18
    v_mul_f32 v115, v19, v19
    v_mul_f32 v116, v20, v20
    v_mul_f32 v117, v21, v21
    v_mul_f32 v118, v22, v22
    v_mul_f32 v119, v23, v23
    v_mul_f32 v128, v24, v24
    v_mul_f32 v129, v25, v25
    v_mul_f32 v130, v26, v26
    v_mul_f32 v131, v27, v27
    v_mul_f32 v132, v28, v28
    v_mul_f32 v133, v29, v29
    v_mul_f32 v134, v30, v30
    v_mul_f32 v135, v31, v31
    v_fma_f32 v112, v112, v109, v108
    v_fma_f32 v113, v113, v109, v108
    v_fma_f32 v114, v114, v109, v108
    v_fma_f32 v115, v115, v109, v108
    v_fma_f32 v116, v116, v109, v108
    v_fma_f32 v117, v117, v109, v108
    v_fma_f32 v118, v118, v109, v108
    v_fma_f32 v119, v119, v109, v108
    v_fma_f32 v128, v128, v109, v108
    v_fma_f32 v129, v129, v109, v108
    v_fma_f32 v130, v130, v109, v108
    v_fma_f32 v131, v131, v109, v108
    v_fma_f32 v132, v132, v109, v108
    v_fma_f32 v133, v133, v109, v108
    v_fma_f32 v134, v134, v109, v108
    v_fma_f32 v135, v135, v109, v108
    v_mul_f32 v112, v112, v16
    v_mul_f32 v113, v113, v17
    v_mul_f32 v114, v114, v18
    v_mul_f32 v115, v115, v19
    v_mul_f32 v116, v116, v20
    v_mul_f32 v117, v117, v21
    v_mul_f32 v118, v118, v22
    v_mul_f32 v119, v119, v23
    v_mul_f32 v128, v128, v24
    v_mul_f32 v129, v129, v25
    v_mul_f32 v130, v130, v26
    v_mul_f32 v131, v131, v27
    v_mul_f32 v132, v132, v28
    v_mul_f32 v133, v133, v29
    v_mul_f32 v134, v134, v30
    v_mul_f32 v135, v135, v31
    v_exp_f32 v112, v112
    v_exp_f32 v113, v113
    v_exp_f32 v114, v114
    v_exp_f32 v115, v115
    v_exp_f32 v116, v116
    v_exp_f32 v117, v117
    v_exp_f32 v118, v118
    v_exp_f32 v119, v119
    v_exp_f32 v128, v128
    v_exp_f32 v129, v129
    v_exp_f32 v130, v130
    v_exp_f32 v131, v131
    v_exp_f32 v132, v132
    v_exp_f32 v133, v133
    v_exp_f32 v134, v134
    v_exp_f32 v135, v135
    v_add_f32 v112, 1.0, v112
    v_add_f32 v113, 1.0, v113
    v_add_f32 v114, 1.0, v114
    v_add_f32 v115, 1.0, v115
    v_add_f32 v116, 1.0, v116
    v_add_f32 v117, 1.0, v117
    v_add_f32 v118, 1.0, v118
    v_add_f32 v119, 1.0, v119
    v_add_f32 v128, 1.0, v128
    v_add_f32 v129, 1.0, v129
    v_add_f32 v130, 1.0, v130
    v_add_f32 v131, 1.0, v131
    v_add_f32 v132, 1.0, v132
    v_add_f32 v133, 1.0, v133
    v_add_f32 v134, 1.0, v134
    v_add_f32 v135, 1.0, v135
    v_rcp_f32 v112, v112
    v_rcp_f32 v113, v113
    v_rcp_f32 v114, v114
    v_rcp_f32 v115, v115
    v_rcp_f32 v116, v116
    v_rcp_f32 v117, v117
    v_rcp_f32 v118, v118
    v_rcp_f32 v119, v119
    v_rcp_f32 v128, v128
    v_rcp_f32 v129, v129
    v_rcp_f32 v130, v130
    v_rcp_f32 v131, v131
    v_rcp_f32 v132, v132
    v_rcp_f32 v133, v133
    v_rcp_f32 v134, v134
    v_rcp_f32 v135, v135
    v_mul_f32 v16, v16, v112
    v_mul_f32 v17, v17, v113
    v_mul_f32 v18, v18, v114
    v_mul_f32 v19, v19, v115
    v_mul_f32 v20, v20, v116
    v_mul_f32 v21, v21, v117
    v_mul_f32 v22, v22, v118
    v_mul_f32 v23, v23, v119
    v_mul_f32 v24, v24, v128
    v_mul_f32 v25, v25, v129
    v_mul_f32 v26, v26, v130
    v_mul_f32 v27, v27, v131
    v_mul_f32 v28, v28, v132
    v_mul_f32 v29, v29, v133
    v_mul_f32 v30, v30, v134
    v_mul_f32 v31, v31, v135
    v_cvt_pk_bf16_f32 v64, v16, v17
    v_cvt_pk_bf16_f32 v65, v18, v19
    v_cvt_pk_bf16_f32 v66, v20, v21
    v_cvt_pk_bf16_f32 v67, v22, v23
    v_cvt_pk_bf16_f32 v68, v24, v25
    v_cvt_pk_bf16_f32 v69, v26, v27
    v_cvt_pk_bf16_f32 v70, v28, v29
    v_cvt_pk_bf16_f32 v71, v30, v31
    global_store_dwordx4 v96, v[64:67], s[40:41] offset:0 sc0 sc1
    global_store_dwordx4 v96, v[68:71], s[40:41] offset:1024 sc0 sc1
    v_fma_f32 v32, v72, v106, v32
    v_fma_f32 v33, v73, v106, v33
    v_fma_f32 v34, v74, v106, v34
    v_fma_f32 v35, v75, v106, v35
    v_fma_f32 v36, v76, v106, v36
    v_fma_f32 v37, v77, v106, v37
    v_fma_f32 v38, v78, v106, v38
    v_fma_f32 v39, v79, v106, v39
    v_fma_f32 v40, v80, v106, v40
    v_fma_f32 v41, v81, v106, v41
    v_fma_f32 v42, v82, v106, v42
    v_fma_f32 v43, v83, v106, v43
    v_fma_f32 v44, v84, v106, v44
    v_fma_f32 v45, v85, v106, v45
    v_fma_f32 v46, v86, v106, v46
    v_fma_f32 v47, v87, v106, v47
    v_mul_f32 v32, v32, v107
    v_mul_f32 v33, v33, v107
    v_mul_f32 v34, v34, v107
    v_mul_f32 v35, v35, v107
    v_mul_f32 v36, v36, v107
    v_mul_f32 v37, v37, v107
    v_mul_f32 v38, v38, v107
    v_mul_f32 v39, v39, v107
    v_mul_f32 v40, v40, v107
    v_mul_f32 v41, v41, v107
    v_mul_f32 v42, v42, v107
    v_mul_f32 v43, v43, v107
    v_mul_f32 v44, v44, v107
    v_mul_f32 v45, v45, v107
    v_mul_f32 v46, v46, v107
    v_mul_f32 v47, v47, v107
    v_cvt_pk_bf16_f32 v32, 0, v32
    v_cvt_pk_bf16_f32 v33, 0, v33
    v_cvt_pk_bf16_f32 v34, 0, v34
    v_cvt_pk_bf16_f32 v35, 0, v35
    v_cvt_pk_bf16_f32 v36, 0, v36
    v_cvt_pk_bf16_f32 v37, 0, v37
    v_cvt_pk_bf16_f32 v38, 0, v38
    v_cvt_pk_bf16_f32 v39, 0, v39
    v_cvt_pk_bf16_f32 v40, 0, v40
    v_cvt_pk_bf16_f32 v41, 0, v41
    v_cvt_pk_bf16_f32 v42, 0, v42
    v_cvt_pk_bf16_f32 v43, 0, v43
    v_cvt_pk_bf16_f32 v44, 0, v44
    v_cvt_pk_bf16_f32 v45, 0, v45
    v_cvt_pk_bf16_f32 v46, 0, v46
    v_cvt_pk_bf16_f32 v47, 0, v47
    v_add_f32 v32, v32, v48
    v_add_f32 v33, v33, v49
    v_add_f32 v34, v34, v50
    v_add_f32 v35, v35, v51
    v_add_f32 v36, v36, v52
    v_add_f32 v37, v37, v53
    v_add_f32 v38, v38, v54
    v_add_f32 v39, v39, v55
    v_add_f32 v40, v40, v56
    v_add_f32 v41, v41, v57
    v_add_f32 v42, v42, v58
    v_add_f32 v43, v43, v59
    v_add_f32 v44, v44, v60
    v_add_f32 v45, v45, v61
    v_add_f32 v46, v46, v62
    v_add_f32 v47, v47, v63
    v_cvt_pk_bf16_f32 v32, 0, v32
    v_cvt_pk_bf16_f32 v33, 0, v33
    v_cvt_pk_bf16_f32 v34, 0, v34
    v_cvt_pk_bf16_f32 v35, 0, v35
    v_cvt_pk_bf16_f32 v36, 0, v36
    v_cvt_pk_bf16_f32 v37, 0, v37
    v_cvt_pk_bf16_f32 v38, 0, v38
    v_cvt_pk_bf16_f32 v39, 0, v39
    v_cvt_pk_bf16_f32 v40, 0, v40
    v_cvt_pk_bf16_f32 v41, 0, v41
    v_cvt_pk_bf16_f32 v42, 0, v42
    v_cvt_pk_bf16_f32 v43, 0, v43
    v_cvt_pk_bf16_f32 v44, 0, v44
    v_cvt_pk_bf16_f32 v45, 0, v45
    v_cvt_pk_bf16_f32 v46, 0, v46
    v_cvt_pk_bf16_f32 v47, 0, v47
    v_mul_f32 v112, v32, v32
    v_mul_f32 v113, v33, v33
    v_mul_f32 v114, v34, v34
    v_mul_f32 v115, v35, v35
    v_mul_f32 v116, v36, v36
    v_mul_f32 v117, v37, v37
    v_mul_f32 v118, v38, v38
    v_mul_f32 v119, v39, v39
    v_mul_f32 v128, v40, v40
    v_mul_f32 v129, v41, v41
    v_mul_f32 v130, v42, v42
    v_mul_f32 v131, v43, v43
    v_mul_f32 v132, v44, v44
    v_mul_f32 v133, v45, v45
    v_mul_f32 v134, v46, v46
    v_mul_f32 v135, v47, v47
    v_fma_f32 v112, v112, v109, v108
    v_fma_f32 v113, v113, v109, v108
    v_fma_f32 v114, v114, v109, v108
    v_fma_f32 v115, v115, v109, v108
    v_fma_f32 v116, v116, v109, v108
    v_fma_f32 v117, v117, v109, v108
    v_fma_f32 v118, v118, v109, v108
    v_fma_f32 v119, v119, v109, v108
    v_fma_f32 v128, v128, v109, v108
    v_fma_f32 v129, v129, v109, v108
    v_fma_f32 v130, v130, v109, v108
    v_fma_f32 v131, v131, v109, v108
    v_fma_f32 v132, v132, v109, v108
    v_fma_f32 v133, v133, v109, v108
    v_fma_f32 v134, v134, v109, v108
    v_fma_f32 v135, v135, v109, v108
    v_mul_f32 v112, v112, v32
    v_mul_f32 v113, v113, v33
    v_mul_f32 v114, v114, v34
    v_mul_f32 v115, v115, v35
    v_mul_f32 v116, v116, v36
    v_mul_f32 v117, v117, v37
    v_mul_f32 v118, v118, v38
    v_mul_f32 v119, v119, v39
    v_mul_f32 v128, v128, v40
    v_mul_f32 v129, v129, v41
    v_mul_f32 v130, v130, v42
    v_mul_f32 v131, v131, v43
    v_mul_f32 v132, v132, v44
    v_mul_f32 v133, v133, v45
    v_mul_f32 v134, v134, v46
    v_mul_f32 v135, v135, v47
    v_exp_f32 v112, v112
    v_exp_f32 v113, v113
    v_exp_f32 v114, v114
    v_exp_f32 v115, v115
    v_exp_f32 v116, v116
    v_exp_f32 v117, v117
    v_exp_f32 v118, v118
    v_exp_f32 v119, v119
    v_exp_f32 v128, v128
    v_exp_f32 v129, v129
    v_exp_f32 v130, v130
    v_exp_f32 v131, v131
    v_exp_f32 v132, v132
    v_exp_f32 v133, v133
    v_exp_f32 v134, v134
    v_exp_f32 v135, v135
    v_add_f32 v112, 1.0, v112
    v_add_f32 v113, 1.0, v113
    v_add_f32 v114, 1.0, v114
    v_add_f32 v115, 1.0, v115
    v_add_f32 v116, 1.0, v116
    v_add_f32 v117, 1.0, v117
    v_add_f32 v118, 1.0, v118
    v_add_f32 v119, 1.0, v119
    v_add_f32 v128, 1.0, v128
    v_add_f32 v129, 1.0, v129
    v_add_f32 v130, 1.0, v130
    v_add_f32 v131, 1.0, v131
    v_add_f32 v132, 1.0, v132
    v_add_f32 v133, 1.0, v133
    v_add_f32 v134, 1.0, v134
    v_add_f32 v135, 1.0, v135
    v_rcp_f32 v112, v112
    v_rcp_f32 v113, v113
    v_rcp_f32 v114, v114
    v_rcp_f32 v115, v115
    v_rcp_f32 v116, v116
    v_rcp_f32 v117, v117
    v_rcp_f32 v118, v118
    v_rcp_f32 v119, v119
    v_rcp_f32 v128, v128
    v_rcp_f32 v129, v129
    v_rcp_f32 v130, v130
    v_rcp_f32 v131, v131
    v_rcp_f32 v132, v132
    v_rcp_f32 v133, v133
    v_rcp_f32 v134, v134
    v_rcp_f32 v135, v135
    v_mul_f32 v32, v32, v112
    v_mul_f32 v33, v33, v113
    v_mul_f32 v34, v34, v114
    v_mul_f32 v35, v35, v115
    v_mul_f32 v36, v36, v116
    v_mul_f32 v37, v37, v117
    v_mul_f32 v38, v38, v118
    v_mul_f32 v39, v39, v119
    v_mul_f32 v40, v40, v128
    v_mul_f32 v41, v41, v129
    v_mul_f32 v42, v42, v130
    v_mul_f32 v43, v43, v131
    v_mul_f32 v44, v44, v132
    v_mul_f32 v45, v45, v133
    v_mul_f32 v46, v46, v134
    v_mul_f32 v47, v47, v135
    v_cvt_pk_bf16_f32 v88, v32, v33
    v_cvt_pk_bf16_f32 v89, v34, v35
    v_cvt_pk_bf16_f32 v90, v36, v37
    v_cvt_pk_bf16_f32 v91, v38, v39
    v_cvt_pk_bf16_f32 v92, v40, v41
    v_cvt_pk_bf16_f32 v93, v42, v43
    v_cvt_pk_bf16_f32 v94, v44, v45
    v_cvt_pk_bf16_f32 v95, v46, v47
    buffer_load_dwordx4 v[104:107], v15, s[44:47], s56 offen offset:0 sc1
    buffer_load_dwordx4 v[108:111], v15, s[44:47], s56 offen offset:1024 sc1
    buffer_load_dwordx4 v[112:115], v15, s[44:47], s57 offen offset:0 sc1
    buffer_load_dwordx4 v[116:119], v15, s[44:47], s57 offen offset:1024 sc1
    buffer_load_dwordx4 v[120:123], v15, s[44:47], s58 offen offset:0 sc1
    buffer_load_dwordx4 v[124:127], v15, s[44:47], s58 offen offset:1024 sc1
    buffer_load_dwordx4 v[128:131], v15, s[44:47], s59 offen offset:0 sc1
    buffer_load_dwordx4 v[132:135], v15, s[44:47], s59 offen offset:1024 sc1
    buffer_load_dwordx4 v[136:139], v15, s[44:47], s60 offen offset:0 sc1
    buffer_load_dwordx4 v[140:143], v15, s[44:47], s60 offen offset:1024 sc1
    global_store_dwordx4 v97, v[88:91], s[40:41] offset:0 sc0 sc1
    global_store_dwordx4 v97, v[92:95], s[40:41] offset:1024 sc0 sc1
    s_setprio 0
    s_lshl_b32 s15, s6, 6
    s_lshl_b32 s12, s5, 6
    v_and_b32 v8, 7, v0
    v_lshl_add_u32 v9, v8, 3, s15
    v_lshrrev_b32 v10, 3, v0
    v_add_u32 v11, s12, v10
    v_lshlrev_b32 v12, 1, v9
    v_mul_u32_u24 v13, 896, v11
    v_lshl_add_u32 v13, v9, 1, v13
    global_load_dwordx4 v[100:103], v12, s[36:37]
    s_mov_b32 s20, 0
    s_waitcnt vmcnt(39)
    v_mfma_f32_32x32x16_bf16 v[16:31], v[144:147], v[64:67], 0
    v_mfma_f32_32x32x16_bf16 v[32:47], v[148:151], v[64:67], 0
    v_mfma_f32_32x32x16_bf16 v[48:63], v[144:147], v[88:91], 0
    v_mfma_f32_32x32x16_bf16 v[72:87], v[148:151], v[88:91], 0
    v_mfma_f32_32x32x16_bf16 v[16:31], v[152:155], v[68:71], v[16:31]
    v_mfma_f32_32x32x16_bf16 v[32:47], v[156:159], v[68:71], v[32:47]
    v_mfma_f32_32x32x16_bf16 v[48:63], v[152:155], v[92:95], v[48:63]
    v_mfma_f32_32x32x16_bf16 v[72:87], v[156:159], v[92:95], v[72:87]
    buffer_load_dwordx4 v[144:147], v15, s[44:47], s61 offen offset:0 sc1
    buffer_load_dwordx4 v[148:151], v15, s[44:47], s61 offen offset:1024 sc1
    v_lshrrev_b32 v3, 2, v8
    v_lshrrev_b32 v4, 5, v10
    v_lshl_add_u32 v3, v3, 1, v4
    v_mul_u32_u24 v3, 4416, v3
    v_and_b32 v4, 3, v8
    v_mul_u32_u24 v4, 1056, v4
    v_and_b32 v5, 31, v10
    v_lshlrev_b32 v5, 4, v5
    v_add3_u32 v11, v3, v4, v5
    v_mul_u32_u24 v12, 1040, v8
    v_lshl_add_u32 v12, v10, 1, v12
    v_add_u32 v12, 141312, v12
    s_mul_i32 s14, s4, 17664
    s_mul_i32 s15, s10, 4416
    s_add_u32 s15, s15, s14
    v_lshl_add_u32 v8, v2, 4, s15
    s_mul_i32 s15, s11, 4416
    s_add_u32 s15, s15, s14
    v_lshl_add_u32 v9, v2, 4, s15
    s_waitcnt vmcnt(14)
    v_cmp_eq_u32 vcc, -1, v104
    s_cbranch_vccnz K3_r0
K3_b0:
    v_mfma_f32_32x32x16_bf16 v[16:31], v[160:163], v[104:107], v[16:31]
    v_mfma_f32_32x32x16_bf16 v[32:47], v[164:167], v[104:107], v[32:47]
    buffer_load_dwordx4 v[152:155], v98, s[44:47], s56 offen offset:0 sc1
    buffer_load_dwordx4 v[156:159], v98, s[44:47], s56 offen offset:1024 sc1
    s_waitcnt vmcnt(15)
    v_cmp_eq_u32 vcc, -1, v108
    s_cbranch_vccnz K3_r1
K3_b1:
    v_mfma_f32_32x32x16_bf16 v[16:31], v[168:171], v[108:111], v[16:31]
    v_mfma_f32_32x32x16_bf16 v[32:47], v[172:175], v[108:111], v[32:47]
    buffer_load_dwordx4 v[64:67], v98, s[44:47], s57 offen offset:0 sc1
    buffer_load_dwordx4 v[68:71], v98, s[44:47], s57 offen offset:1024 sc1
    s_waitcnt vmcnt(16)
    v_cmp_eq_u32 vcc, -1, v112
    s_cbranch_vccnz K3_r2
K3_b2:
    v_mfma_f32_32x32x16_bf16 v[16:31], v[176:179], v[112:115], v[16:31]
    v_mfma_f32_32x32x16_bf16 v[32:47], v[180:183], v[112:115], v[32:47]
    buffer_load_dwordx4 v[88:91], v98, s[44:47], s58 offen offset:0 sc1
    buffer_load_dwordx4 v[92:95], v98, s[44:47], s58 offen offset:1024 sc1
    s_waitcnt vmcnt(17)
    v_cmp_eq_u32 vcc, -1, v116
    s_cbranch_vccnz K3_r3
K3_b3:
    v_mfma_f32_32x32x16_bf16 v[16:31], v[184:187], v[116:119], v[16:31]
    v_mfma_f32_32x32x16_bf16 v[32:47], v[188:191], v[116:119], v[32:47]
    buffer_load_dwordx4 v[104:107], v98, s[44:47], s59 offen offset:0 sc1
    buffer_load_dwordx4 v[108:111], v98, s[44:47], s59 offen offset:1024 sc1
    s_waitcnt vmcnt(18)
    v_cmp_eq_u32 vcc, -1, v120
    s_cbranch_vccnz K3_r4
K3_b4:
    v_mfma_f32_32x32x16_bf16 v[16:31], v[192:195], v[120:123], v[16:31]
    v_mfma_f32_32x32x16_bf16 v[32:47], v[196:199], v[120:123], v[32:47]
    buffer_load_dwordx4 v[112:115], v98, s[44:47], s60 offen offset:0 sc1
    buffer_load_dwordx4 v[116:119], v98, s[44:47], s60 offen offset:1024 sc1
    s_waitcnt vmcnt(19)
    v_cmp_eq_u32 vcc, -1, v124
    s_cbranch_vccnz K3_r5
K3_b5:
    v_mfma_f32_32x32x16_bf16 v[16:31], v[200:203], v[124:127], v[16:31]
    v_mfma_f32_32x32x16_bf16 v[32:47], v[204:207], v[124:127], v[32:47]
    buffer_load_dwordx4 v[120:123], v98, s[44:47], s61 offen offset:0 sc1
    buffer_load_dwordx4 v[124:127], v98, s[44:47], s61 offen offset:1024 sc1
    global_load_dword v7, v13, s[38:39]
    s_waitcnt vmcnt(21)
    v_cmp_eq_u32 vcc, -1, v128
    s_cbranch_vccnz K3_r6
K3_b6:
    v_mfma_f32_32x32x16_bf16 v[16:31], v[208:211], v[128:131], v[16:31]
    v_mfma_f32_32x32x16_bf16 v[32:47], v[212:215], v[128:131], v[32:47]
    s_waitcnt vmcnt(20)
    v_cmp_eq_u32 vcc, -1, v132
    s_cbranch_vccnz K3_r7
K3_b7:
    v_mfma_f32_32x32x16_bf16 v[16:31], v[216:219], v[132:135], v[16:31]
    v_mfma_f32_32x32x16_bf16 v[32:47], v[220:223], v[132:135], v[32:47]
    s_waitcnt vmcnt(19)
    v_cmp_eq_u32 vcc, -1, v136
    s_cbranch_vccnz K3_r8
K3_b8:
    v_mfma_f32_32x32x16_bf16 v[16:31], v[224:227], v[136:139], v[16:31]
    v_mfma_f32_32x32x16_bf16 v[32:47], v[228:231], v[136:139], v[32:47]
    s_waitcnt vmcnt(18)
    v_cmp_eq_u32 vcc, -1, v140
    s_cbranch_vccnz K3_r9
K3_b9:
    v_mfma_f32_32x32x16_bf16 v[16:31], v[232:235], v[140:143], v[16:31]
    v_mfma_f32_32x32x16_bf16 v[32:47], v[236:239], v[140:143], v[32:47]
    s_waitcnt vmcnt(14)
    v_cmp_eq_u32 vcc, -1, v144
    s_cbranch_vccnz K3_r10
K3_b10:
    v_mfma_f32_32x32x16_bf16 v[16:31], v[240:243], v[144:147], v[16:31]
    v_mfma_f32_32x32x16_bf16 v[32:47], v[244:247], v[144:147], v[32:47]
    s_waitcnt vmcnt(13)
    v_cmp_eq_u32 vcc, -1, v148
    s_cbranch_vccnz K3_r11
K3_b11:
    v_mfma_f32_32x32x16_bf16 v[16:31], v[248:251], v[148:151], v[16:31]
    v_mfma_f32_32x32x16_bf16 v[32:47], v[252:255], v[148:151], v[32:47]
    s_waitcnt vmcnt(12)
    v_cmp_eq_u32 vcc, -1, v152
    s_cbranch_vccnz K3_r12
K3_b12:
    v_mfma_f32_32x32x16_bf16 v[48:63], v[160:163], v[152:155], v[48:63]
    v_mfma_f32_32x32x16_bf16 v[72:87], v[164:167], v[152:155], v[72:87]
    s_waitcnt vmcnt(11)
    v_cmp_eq_u32 vcc, -1, v156
    s_cbranch_vccnz K3_r13
K3_b13:
    v_mfma_f32_32x32x16_bf16 v[48:63], v[168:171], v[156:159], v[48:63]
    v_mfma_f32_32x32x16_bf16 v[72:87], v[172:175], v[156:159], v[72:87]
    s_waitcnt vmcnt(10)
    v_cmp_eq_u32 vcc, -1, v64
    s_cbranch_vccnz K3_r14
K3_b14:
    v_mfma_f32_32x32x16_bf16 v[48:63], v[176:179], v[64:67], v[48:63]
    v_mfma_f32_32x32x16_bf16 v[72:87], v[180:183], v[64:67], v[72:87]
    s_waitcnt vmcnt(9)
    v_cmp_eq_u32 vcc, -1, v68
    s_cbranch_vccnz K3_r15
K3_b15:
    v_mfma_f32_32x32x16_bf16 v[48:63], v[184:187], v[68:71], v[48:63]
    v_mfma_f32_32x32x16_bf16 v[72:87], v[188:191], v[68:71], v[72:87]
    s_waitcnt vmcnt(8)
    v_cmp_eq_u32 vcc, -1, v88
    s_cbranch_vccnz K3_r16
K3_b16:
    v_mfma_f32_32x32x16_bf16 v[48:63], v[192:195], v[88:91], v[48:63]
    v_mfma_f32_32x32x16_bf16 v[72:87], v[196:199], v[88:91], v[72:87]
    s_waitcnt vmcnt(7)
    v_cmp_eq_u32 vcc, -1, v92
    s_cbranch_vccnz K3_r17
K3_b17:
    v_mfma_f32_32x32x16_bf16 v[48:63], v[200:203], v[92:95], v[48:63]
    v_mfma_f32_32x32x16_bf16 v[72:87], v[204:207], v[92:95], v[72:87]
    s_waitcnt vmcnt(6)
    v_cmp_eq_u32 vcc, -1, v104
    s_cbranch_vccnz K3_r18
K3_b18:
    v_mfma_f32_32x32x16_bf16 v[48:63], v[208:211], v[104:107], v[48:63]
    v_mfma_f32_32x32x16_bf16 v[72:87], v[212:215], v[104:107], v[72:87]
    s_waitcnt vmcnt(5)
    v_cmp_eq_u32 vcc, -1, v108
    s_cbranch_vccnz K3_r19
K3_b19:
    v_mfma_f32_32x32x16_bf16 v[48:63], v[216:219], v[108:111], v[48:63]
    v_mfma_f32_32x32x16_bf16 v[72:87], v[220:223], v[108:111], v[72:87]
    s_waitcnt vmcnt(4)
    v_cmp_eq_u32 vcc, -1, v112
    s_cbranch_vccnz K3_r20
K3_b20:
    v_mfma_f32_32x32x16_bf16 v[48:63], v[224:227], v[112:115], v[48:63]
    v_mfma_f32_32x32x16_bf16 v[72:87], v[228:231], v[112:115], v[72:87]
    s_waitcnt vmcnt(3)
    v_cmp_eq_u32 vcc, -1, v116
    s_cbranch_vccnz K3_r21
K3_b21:
    v_mfma_f32_32x32x16_bf16 v[48:63], v[232:235], v[116:119], v[48:63]
    v_mfma_f32_32x32x16_bf16 v[72:87], v[236:239], v[116:119], v[72:87]
    s_waitcnt vmcnt(2)
    v_cmp_eq_u32 vcc, -1, v120
    s_cbranch_vccnz K3_r22
K3_b22:
    v_mfma_f32_32x32x16_bf16 v[48:63], v[240:243], v[120:123], v[48:63]
    v_mfma_f32_32x32x16_bf16 v[72:87], v[244:247], v[120:123], v[72:87]
    s_waitcnt vmcnt(1)
    v_cmp_eq_u32 vcc, -1, v124
    s_cbranch_vccnz K3_r23
K3_b23:
    v_mfma_f32_32x32x16_bf16 v[48:63], v[248:251], v[124:127], v[48:63]
    v_mfma_f32_32x32x16_bf16 v[72:87], v[252:255], v[124:127], v[72:87]
K3_cw:
    ds_read_b32 v3, v99 offset:4
    s_waitcnt lgkmcnt(0)
    v_readfirstlane_b32 s12, v3
    s_nop 0
    s_cmp_lt_u32 s12, 8
    s_cbranch_scc1 K3_cw
    ds_write_b128 v8, v[16:19] offset:0
    ds_write_b128 v8, v[20:23] offset:1056
    ds_write_b128 v8, v[24:27] offset:2112
    ds_write_b128 v8, v[28:31] offset:3168
    ds_write_b128 v8, v[32:35] offset:8832
    ds_write_b128 v8, v[36:39] offset:9888
    ds_write_b128 v8, v[40:43] offset:10944
    ds_write_b128 v8, v[44:47] offset:12000
    ds_write_b128 v9, v[48:51] offset:0
    ds_write_b128 v9, v[52:55] offset:1056
    ds_write_b128 v9, v[56:59] offset:2112
    ds_write_b128 v9, v[60:63] offset:3168
    ds_write_b128 v9, v[72:75] offset:8832
    ds_write_b128 v9, v[76:79] offset:9888
    ds_write_b128 v9, v[80:83] offset:10944
    ds_write_b128 v9, v[84:87] offset:12000
    v_add_u32 v3, 70656, v11
    s_waitcnt lgkmcnt(0)
    s_barrier
    ds_read_u16 v104, v12 offset:0
    ds_read_u16 v105, v12 offset:128
    ds_read_u16 v106, v12 offset:256
    ds_read_u16 v107, v12 offset:384
    ds_read_u16 v108, v12 offset:512
    ds_read_u16 v109, v12 offset:640
    ds_read_u16 v110, v12 offset:768
    ds_read_u16 v111, v12 offset:896
    ds_read_b128 v[144:147], v11 offset:0
    ds_read_b128 v[148:151], v11 offset:512
    ds_read_b128 v[152:155], v11 offset:17664
    ds_read_b128 v[156:159], v11 offset:18176
    ds_read_b128 v[160:163], v11 offset:35328
    ds_read_b128 v[164:167], v11 offset:35840
    ds_read_b128 v[168:171], v11 offset:52992
    ds_read_b128 v[172:175], v11 offset:53504
    ds_read_b128 v[176:179], v3 offset:0
    ds_read_b128 v[180:183], v3 offset:512
    ds_read_b128 v[184:187], v3 offset:17664
    ds_read_b128 v[188:191], v3 offset:18176
    ds_read_b128 v[192:195], v3 offset:35328
    ds_read_b128 v[196:199], v3 offset:35840
    ds_read_b128 v[200:203], v3 offset:52992
    ds_read_b128 v[204:207], v3 offset:53504
    v_lshlrev_b32 v16, 16, v100
    v_and_b32 v17, 0xffff0000, v100
    v_lshlrev_b32 v18, 16, v101
    v_and_b32 v19, 0xffff0000, v101
    v_lshlrev_b32 v20, 16, v102
    v_and_b32 v21, 0xffff0000, v102
    v_lshlrev_b32 v22, 16, v103
    v_and_b32 v23, 0xffff0000, v103
    s_waitcnt lgkmcnt(15)
    v_lshlrev_b32 v104, 16, v104
    v_lshlrev_b32 v105, 16, v105
    v_lshlrev_b32 v106, 16, v106
    v_lshlrev_b32 v107, 16, v107
    v_lshlrev_b32 v108, 16, v108
    v_lshlrev_b32 v109, 16, v109
    v_lshlrev_b32 v110, 16, v110
    v_lshlrev_b32 v111, 16, v111
    s_waitcnt lgkmcnt(12)
    v_add_f32 v144, v144, v152
    v_add_f32 v145, v145, v153
    v_add_f32 v146, v146, v154
    v_add_f32 v147, v147, v155
    v_add_f32 v148, v148, v156
    v_add_f32 v149, v149, v157
    v_add_f32 v150, v150, v158
    v_add_f32 v151, v151, v159
    s_waitcnt lgkmcnt(8)
    v_add_f32 v160, v160, v168
    v_add_f32 v161, v161, v169
    v_add_f32 v162, v162, v170
    v_add_f32 v163, v163, v171
    v_add_f32 v164, v164, v172
    v_add_f32 v165, v165, v173
    v_add_f32 v166, v166, v174
    v_add_f32 v167, v167, v175
    s_waitcnt lgkmcnt(4)
    v_add_f32 v176, v176, v184
    v_add_f32 v177, v177, v185
    v_add_f32 v178, v178, v186
    v_add_f32 v179, v179, v187
    v_add_f32 v180, v180, v188
    v_add_f32 v181, v181, v189
    v_add_f32 v182, v182, v190
    v_add_f32 v183, v183, v191
    s_waitcnt lgkmcnt(0)
    v_add_f32 v192, v192, v200
    v_add_f32 v193, v193, v201
    v_add_f32 v194, v194, v202
    v_add_f32 v195, v195, v203
    v_add_f32 v196, v196, v204
    v_add_f32 v197, v197, v205
    v_add_f32 v198, v198, v206
    v_add_f32 v199, v199, v207
    v_add_f32 v144, v144, v160
    v_add_f32 v176, v176, v192
    v_add_f32 v145, v145, v161
    v_add_f32 v177, v177, v193
    v_add_f32 v146, v146, v162
    v_add_f32 v178, v178, v194
    v_add_f32 v147, v147, v163
    v_add_f32 v179, v179, v195
    v_add_f32 v148, v148, v164
    v_add_f32 v180, v180, v196
    v_add_f32 v149, v149, v165
    v_add_f32 v181, v181, v197
    v_add_f32 v150, v150, v166
    v_add_f32 v182, v182, v198
    v_add_f32 v151, v151, v167
    v_add_f32 v183, v183, v199
    v_add_f32 v144, v144, v176
    v_add_f32 v145, v145, v177
    v_add_f32 v146, v146, v178
    v_add_f32 v147, v147, v179
    v_add_f32 v148, v148, v180
    v_add_f32 v149, v149, v181
    v_add_f32 v150, v150, v182
    v_add_f32 v151, v151, v183
    v_cvt_pk_bf16_f32 v152, v144, v145
    v_cvt_pk_bf16_f32 v153, v146, v147
    v_cvt_pk_bf16_f32 v154, v148, v149
    v_cvt_pk_bf16_f32 v155, v150, v151
    v_lshlrev_b32 v144, 16, v152
    v_and_b32 v145, 0xffff0000, v152
    v_lshlrev_b32 v146, 16, v153
    v_and_b32 v147, 0xffff0000, v153
    v_lshlrev_b32 v148, 16, v154
    v_and_b32 v149, 0xffff0000, v154
    v_lshlrev_b32 v150, 16, v155
    v_and_b32 v151, 0xffff0000, v155
    v_add_f32 v144, v144, v16
    v_add_f32 v145, v145, v17
    v_add_f32 v146, v146, v18
    v_add_f32 v147, v147, v19
    v_add_f32 v148, v148, v20
    v_add_f32 v149, v149, v21
    v_add_f32 v150, v150, v22
    v_add_f32 v151, v151, v23
    v_cvt_pk_bf16_f32 v152, v144, v145
    v_cvt_pk_bf16_f32 v153, v146, v147
    v_cvt_pk_bf16_f32 v154, v148, v149
    v_cvt_pk_bf16_f32 v155, v150, v151
    v_lshlrev_b32 v144, 16, v152
    v_and_b32 v145, 0xffff0000, v152
    v_lshlrev_b32 v146, 16, v153
    v_and_b32 v147, 0xffff0000, v153
    v_lshlrev_b32 v148, 16, v154
    v_and_b32 v149, 0xffff0000, v154
    v_lshlrev_b32 v150, 16, v155
    v_and_b32 v151, 0xffff0000, v155
    v_add_f32 v144, v144, v104
    v_add_f32 v145, v145, v105
    v_add_f32 v146, v146, v106
    v_add_f32 v147, v147, v107
    v_add_f32 v148, v148, v108
    v_add_f32 v149, v149, v109
    v_add_f32 v150, v150, v110
    v_add_f32 v151, v151, v111
    v_cvt_pk_bf16_f32 v160, v144, v145
    v_cvt_pk_bf16_f32 v161, v146, v147
    v_cvt_pk_bf16_f32 v162, v148, v149
    v_cvt_pk_bf16_f32 v163, v150, v151
    global_store_dwordx4 v13, v[160:163], s[38:39] sc0 sc1
K3_exit:
    s_endpgm
K3_r0:
    s_add_u32 s20, s20, 1
    s_cmp_gt_u32 s20, 200000
    s_cbranch_scc1 K3_b0
    buffer_load_dwordx4 v[104:107], v15, s[44:47], s56 offen offset:0 sc1
    buffer_load_dwordx4 v[108:111], v15, s[44:47], s56 offen offset:1024 sc1
    buffer_load_dwordx4 v[112:115], v15, s[44:47], s57 offen offset:0 sc1
    buffer_load_dwordx4 v[116:119], v15, s[44:47], s57 offen offset:1024 sc1
    s_waitcnt vmcnt(0)
    v_cmp_eq_u32 vcc, -1, v104
    s_cbranch_vccnz K3_r0
    s_branch K3_b0
K3_r1:
    s_add_u32 s20, s20, 1
    s_cmp_gt_u32 s20, 200000
    s_cbranch_scc1 K3_b1
    buffer_load_dwordx4 v[108:111], v15, s[44:47], s56 offen offset:1024 sc1
    buffer_load_dwordx4 v[112:115], v15, s[44:47], s57 offen offset:0 sc1
    buffer_load_dwordx4 v[116:119], v15, s[44:47], s57 offen offset:1024 sc1
    buffer_load_dwordx4 v[120:123], v15, s[44:47], s58 offen offset:0 sc1
    s_waitcnt vmcnt(0)
    v_cmp_eq_u32 vcc, -1, v108
    s_cbranch_vccnz K3_r1
    s_branch K3_b1
K3_r2:
    s_add_u32 s20, s20, 1
    s_cmp_gt_u32 s20, 200000
    s_cbranch_scc1 K3_b2
    buffer_load_dwordx4 v[112:115], v15, s[44:47], s57 offen offset:0 sc1
    buffer_load_dwordx4 v[116:119], v15, s[44:47], s57 offen offset:1024 sc1
    buffer_load_dwordx4 v[120:123], v15, s[44:47], s58 offen offset:0 sc1
    buffer_load_dwordx4 v[124:127], v15, s[44:47], s58 offen offset:1024 sc1
    s_waitcnt vmcnt(0)
    v_cmp_eq_u32 vcc, -1, v112
    s_cbranch_vccnz K3_r2
    s_branch K3_b2
K3_r3:
    s_add_u32 s20, s20, 1
    s_cmp_gt_u32 s20, 200000
    s_cbranch_scc1 K3_b3
    buffer_load_dwordx4 v[116:119], v15, s[44:47], s57 offen offset:1024 sc1
    buffer_load_dwordx4 v[120:123], v15, s[44:47], s58 offen offset:0 sc1
    buffer_load_dwordx4 v[124:127], v15, s[44:47], s58 offen offset:1024 sc1
    buffer_load_dwordx4 v[128:131], v15, s[44:47], s59 offen offset:0 sc1
    s_waitcnt vmcnt(0)
    v_cmp_eq_u32 vcc, -1, v116
    s_cbranch_vccnz K3_r3
    s_branch K3_b3
K3_r4:
    s_add_u32 s20, s20, 1
    s_cmp_gt_u32 s20, 200000
    s_cbranch_scc1 K3_b4
    buffer_load_dwordx4 v[120:123], v15, s[44:47], s58 offen offset:0 sc1
    buffer_load_dwordx4 v[124:127], v15, s[44:47], s58 offen offset:1024 sc1
    buffer_load_dwordx4 v[128:131], v15, s[44:47], s59 offen offset:0 sc1
    buffer_load_dwordx4 v[132:135], v15, s[44:47], s59 offen offset:1024 sc1
    s_waitcnt vmcnt(0)
    v_cmp_eq_u32 vcc, -1, v120
    s_cbranch_vccnz K3_r4
    s_branch K3_b4
K3_r5:
    s_add_u32 s20, s20, 1
    s_cmp_gt_u32 s20, 200000
    s_cbranch_scc1 K3_b5
    buffer_load_dwordx4 v[124:127], v15, s[44:47], s58 offen offset:1024 sc1
    buffer_load_dwordx4 v[128:131], v15, s[44:47], s59 offen offset:0 sc1
    buffer_load_dwordx4 v[132:135], v15, s[44:47], s59 offen offset:1024 sc1
    buffer_load_dwordx4 v[136:139], v15, s[44:47], s60 offen offset:0 sc1
    s_waitcnt vmcnt(0)
    v_cmp_eq_u32 vcc, -1, v124
    s_cbranch_vccnz K3_r5
    s_branch K3_b5
K3_r6:
    s_add_u32 s20, s20, 1
    s_cmp_gt_u32 s20, 200000
    s_cbranch_scc1 K3_b6
    buffer_load_dwordx4 v[128:131], v15, s[44:47], s59 offen offset:0 sc1
    buffer_load_dwordx4 v[132:135], v15, s[44:47], s59 offen offset:1024 sc1
    buffer_load_dwordx4 v[136:139], v15, s[44:47], s60 offen offset:0 sc1
    buffer_load_dwordx4 v[140:143], v15, s[44:47], s60 offen offset:1024 sc1
    s_waitcnt vmcnt(0)
    v_cmp_eq_u32 vcc, -1, v128
    s_cbranch_vccnz K3_r6
    s_branch K3_b6
K3_r7:
    s_add_u32 s20, s20, 1
    s_cmp_gt_u32 s20, 200000
    s_cbranch_scc1 K3_b7
    buffer_load_dwordx4 v[132:135], v15, s[44:47], s59 offen offset:1024 sc1
    buffer_load_dwordx4 v[136:139], v15, s[44:47], s60 offen offset:0 sc1
    buffer_load_dwordx4 v[140:143], v15, s[44:47], s60 offen offset:1024 sc1
    buffer_load_dwordx4 v[144:147], v15, s[44:47], s61 offen offset:0 sc1
    s_waitcnt vmcnt(0)
    v_cmp_eq_u32 vcc, -1, v132
    s_cbranch_vccnz K3_r7
    s_branch K3_b7
K3_r8:
    s_add_u32 s20, s20, 1
    s_cmp_gt_u32 s20, 200000
    s_cbranch_scc1 K3_b8
    buffer_load_dwordx4 v[136:139], v15, s[44:47], s60 offen offset:0 sc1
    buffer_load_dwordx4 v[140:143], v15, s[44:47], s60 offen offset:1024 sc1
    buffer_load_dwordx4 v[144:147], v15, s[44:47], s61 offen offset:0 sc1
    buffer_load_dwordx4 v[148:151], v15, s[44:47], s61 offen offset:1024 sc1
    s_waitcnt vmcnt(0)
    v_cmp_eq_u32 vcc, -1, v136
    s_cbranch_vccnz K3_r8
    s_branch K3_b8
K3_r9:
    s_add_u32 s20, s20, 1
    s_cmp_gt_u32 s20, 200000
    s_cbranch_scc1 K3_b9
    buffer_load_dwordx4 v[140:143], v15, s[44:47], s60 offen offset:1024 sc1
    buffer_load_dwordx4 v[144:147], v15, s[44:47], s61 offen offset:0 sc1
    buffer_load_dwordx4 v[148:151], v15, s[44:47], s61 offen offset:1024 sc1
    buffer_load_dwordx4 v[152:155], v98, s[44:47], s56 offen offset:0 sc1
    s_waitcnt vmcnt(0)
    v_cmp_eq_u32 vcc, -1, v140
    s_cbranch_vccnz K3_r9
    s_branch K3_b9
K3_r10:
    s_add_u32 s20, s20, 1
    s_cmp_gt_u32 s20, 200000
    s_cbranch_scc1 K3_b10
    buffer_load_dwordx4 v[144:147], v15, s[44:47], s61 offen offset:0 sc1
    buffer_load_dwordx4 v[148:151], v15, s[44:47], s61 offen offset:1024 sc1
    buffer_load_dwordx4 v[152:155], v98, s[44:47], s56 offen offset:0 sc1
    buffer_load_dwordx4 v[156:159], v98, s[44:47], s56 offen offset:1024 sc1
    s_waitcnt vmcnt(0)
    v_cmp_eq_u32 vcc, -1, v144
    s_cbranch_vccnz K3_r10
    s_branch K3_b10
K3_r11:
    s_add_u32 s20, s20, 1
    s_cmp_gt_u32 s20, 200000
    s_cbranch_scc1 K3_b11
    buffer_load_dwordx4 v[148:151], v15, s[44:47], s61 offen offset:1024 sc1
    buffer_load_dwordx4 v[152:155], v98, s[44:47], s56 offen offset:0 sc1
    buffer_load_dwordx4 v[156:159], v98, s[44:47], s56 offen offset:1024 sc1
    buffer_load_dwordx4 v[64:67], v98, s[44:47], s57 offen offset:0 sc1
    s_waitcnt vmcnt(0)
    v_cmp_eq_u32 vcc, -1, v148
    s_cbranch_vccnz K3_r11
    s_branch K3_b11
K3_r12:
    s_add_u32 s20, s20, 1
    s_cmp_gt_u32 s20, 200000
    s_cbranch_scc1 K3_b12
    buffer_load_dwordx4 v[152:155], v98, s[44:47], s56 offen offset:0 sc1
    buffer_load_dwordx4 v[156:159], v98, s[44:47], s56 offen offset:1024 sc1
    buffer_load_dwordx4 v[64:67], v98, s[44:47], s57 offen offset:0 sc1
    buffer_load_dwordx4 v[68:71], v98, s[44:47], s57 offen offset:1024 sc1
    s_waitcnt vmcnt(0)
    v_cmp_eq_u32 vcc, -1, v152
    s_cbranch_vccnz K3_r12
    s_branch K3_b12
K3_r13:
    s_add_u32 s20, s20, 1
    s_cmp_gt_u32 s20, 200000
    s_cbranch_scc1 K3_b13
    buffer_load_dwordx4 v[156:159], v98, s[44:47], s56 offen offset:1024 sc1
    buffer_load_dwordx4 v[64:67], v98, s[44:47], s57 offen offset:0 sc1
    buffer_load_dwordx4 v[68:71], v98, s[44:47], s57 offen offset:1024 sc1
    buffer_load_dwordx4 v[88:91], v98, s[44:47], s58 offen offset:0 sc1
    s_waitcnt vmcnt(0)
    v_cmp_eq_u32 vcc, -1, v156
    s_cbranch_vccnz K3_r13
    s_branch K3_b13
K3_r14:
    s_add_u32 s20, s20, 1
    s_cmp_gt_u32 s20, 200000
    s_cbranch_scc1 K3_b14
    buffer_load_dwordx4 v[64:67], v98, s[44:47], s57 offen offset:0 sc1
    buffer_load_dwordx4 v[68:71], v98, s[44:47], s57 offen offset:1024 sc1
    buffer_load_dwordx4 v[88:91], v98, s[44:47], s58 offen offset:0 sc1
    buffer_load_dwordx4 v[92:95], v98, s[44:47], s58 offen offset:1024 sc1
    s_waitcnt vmcnt(0)
    v_cmp_eq_u32 vcc, -1, v64
    s_cbranch_vccnz K3_r14
    s_branch K3_b14
K3_r15:
    s_add_u32 s20, s20, 1
    s_cmp_gt_u32 s20, 200000
    s_cbranch_scc1 K3_b15
    buffer_load_dwordx4 v[68:71], v98, s[44:47], s57 offen offset:1024 sc1
    buffer_load_dwordx4 v[88:91], v98, s[44:47], s58 offen offset:0 sc1
    buffer_load_dwordx4 v[92:95], v98, s[44:47], s58 offen offset:1024 sc1
    buffer_load_dwordx4 v[104:107], v98, s[44:47], s59 offen offset:0 sc1
    s_waitcnt vmcnt(0)
    v_cmp_eq_u32 vcc, -1, v68
    s_cbranch_vccnz K3_r15
    s_branch K3_b15
K3_r16:
    s_add_u32 s20, s20, 1
    s_cmp_gt_u32 s20, 200000
    s_cbranch_scc1 K3_b16
    buffer_load_dwordx4 v[88:91], v98, s[44:47], s58 offen offset:0 sc1
    buffer_load_dwordx4 v[92:95], v98, s[44:47], s58 offen offset:1024 sc1
    buffer_load_dwordx4 v[104:107], v98, s[44:47], s59 offen offset:0 sc1
    buffer_load_dwordx4 v[108:111], v98, s[44:47], s59 offen offset:1024 sc1
    s_waitcnt vmcnt(0)
    v_cmp_eq_u32 vcc, -1, v88
    s_cbranch_vccnz K3_r16
    s_branch K3_b16
K3_r17:
    s_add_u32 s20, s20, 1
    s_cmp_gt_u32 s20, 200000
    s_cbranch_scc1 K3_b17
    buffer_load_dwordx4 v[92:95], v98, s[44:47], s58 offen offset:1024 sc1
    buffer_load_dwordx4 v[104:107], v98, s[44:47], s59 offen offset:0 sc1
    buffer_load_dwordx4 v[108:111], v98, s[44:47], s59 offen offset:1024 sc1
    buffer_load_dwordx4 v[112:115], v98, s[44:47], s60 offen offset:0 sc1
    s_waitcnt vmcnt(0)
    v_cmp_eq_u32 vcc, -1, v92
    s_cbranch_vccnz K3_r17
    s_branch K3_b17
K3_r18:
    s_add_u32 s20, s20, 1
    s_cmp_gt_u32 s20, 200000
    s_cbranch_scc1 K3_b18
    buffer_load_dwordx4 v[104:107], v98, s[44:47], s59 offen offset:0 sc1
    buffer_load_dwordx4 v[108:111], v98, s[44:47], s59 offen offset:1024 sc1
    buffer_load_dwordx4 v[112:115], v98, s[44:47], s60 offen offset:0 sc1
    buffer_load_dwordx4 v[116:119], v98, s[44:47], s60 offen offset:1024 sc1
    s_waitcnt vmcnt(0)
    v_cmp_eq_u32 vcc, -1, v104
    s_cbranch_vccnz K3_r18
    s_branch K3_b18
K3_r19:
    s_add_u32 s20, s20, 1
    s_cmp_gt_u32 s20, 200000
    s_cbranch_scc1 K3_b19
    buffer_load_dwordx4 v[108:111], v98, s[44:47], s59 offen offset:1024 sc1
    buffer_load_dwordx4 v[112:115], v98, s[44:47], s60 offen offset:0 sc1
    buffer_load_dwordx4 v[116:119], v98, s[44:47], s60 offen offset:1024 sc1
    buffer_load_dwordx4 v[120:123], v98, s[44:47], s61 offen offset:0 sc1
    s_waitcnt vmcnt(0)
    v_cmp_eq_u32 vcc, -1, v108
    s_cbranch_vccnz K3_r19
    s_branch K3_b19
K3_r20:
    s_add_u32 s20, s20, 1
    s_cmp_gt_u32 s20, 200000
    s_cbranch_scc1 K3_b20
    buffer_load_dwordx4 v[112:115], v98, s[44:47], s60 offen offset:0 sc1
    buffer_load_dwordx4 v[116:119], v98, s[44:47], s60 offen offset:1024 sc1
    buffer_load_dwordx4 v[120:123], v98, s[44:47], s61 offen offset:0 sc1
    buffer_load_dwordx4 v[124:127], v98, s[44:47], s61 offen offset:1024 sc1
    s_waitcnt vmcnt(0)
    v_cmp_eq_u32 vcc, -1, v112
    s_cbranch_vccnz K3_r20
    s_branch K3_b20
K3_r21:
    s_add_u32 s20, s20, 1
    s_cmp_gt_u32 s20, 200000
    s_cbranch_scc1 K3_b21
    buffer_load_dwordx4 v[116:119], v98, s[44:47], s60 offen offset:1024 sc1
    buffer_load_dwordx4 v[120:123], v98, s[44:47], s61 offen offset:0 sc1
    buffer_load_dwordx4 v[124:127], v98, s[44:47], s61 offen offset:1024 sc1
    s_waitcnt vmcnt(0)
    v_cmp_eq_u32 vcc, -1, v116
    s_cbranch_vccnz K3_r21
    s_branch K3_b21
K3_r22:
    s_add_u32 s20, s20, 1
    s_cmp_gt_u32 s20, 200000
    s_cbranch_scc1 K3_b22
    buffer_load_dwordx4 v[120:123], v98, s[44:47], s61 offen offset:0 sc1
    buffer_load_dwordx4 v[124:127], v98, s[44:47], s61 offen offset:1024 sc1
    s_waitcnt vmcnt(0)
    v_cmp_eq_u32 vcc, -1, v120
    s_cbranch_vccnz K3_r22
    s_branch K3_b22
K3_r23:
    s_add_u32 s20, s20, 1
    s_cmp_gt_u32 s20, 200000
    s_cbranch_scc1 K3_b23
    buffer_load_dwordx4 v[124:127], v98, s[44:47], s61 offen offset:1024 sc1
    s_waitcnt vmcnt(0)
    v_cmp_eq_u32 vcc, -1, v124
    s_cbranch_vccnz K3_r23
    s_branch K3_b23
K3_fw:
    s_mov_b32 s20, 0
K3_fw1:
    s_add_u32 s20, s20, 1
    s_cmp_gt_u32 s20, 200000
    s_cbranch_scc1 K3_fok
    global_load_dword v5, v6, s[40:41] sc1
    s_waitcnt vmcnt(0)
    v_cmp_eq_u32 vcc, 0, v5
    s_cbranch_vccnz K3_fw1
    s_branch K3_fok
K3_aw:
    s_mov_b32 s20, 0
K3_aw1:
    s_add_u32 s20, s20, 1
    s_cmp_gt_u32 s20, 200000
    s_cbranch_scc1 K3_aok
    global_load_dword v137, v136, s[40:41] sc1
    s_waitcnt vmcnt(0)
    v_cmp_eq_u32 vcc, 0, v137
    s_cbranch_vccnz K3_aw1
    s_branch K3_aok
K3_helper:
    s_load_dwordx2 s[40:41], s[0:1], 112
    v_lshrrev_b32 v1, 6, v0
    v_and_b32 v2, 63, v0
    v_readfirstlane_b32 s27, v1
    s_and_b32 s4, s2, 7
    s_lshl_b32 s4, s4, 2
    s_lshr_b32 s5, s2, 3
    s_add_u32 s4, s4, s5
    s_lshl_b32 s5, s4, 3
    s_add_u32 s5, s5, s27
    s_mul_i32 s5, s5, 28672
    s_add_u32 s5, s5, 14483456
    v_lshl_add_u32 v3, v2, 4, s5
    v_mov_b32 v4, -1
    v_mov_b32 v5, -1
    v_mov_b32 v6, -1
    v_mov_b32 v7, -1
    s_lshl_b32 s5, s4, 7
    s_add_u32 s5, s5, 21823488
    v_mov_b32 v8, s5
    s_waitcnt lgkmcnt(0)
    s_mul_i32 s5, s4, 14
    s_lshr_b32 s6, s27, 2
    s_add_u32 s5, s5, s6
    s_mul_i32 s5, s5, 4352
    s_and_b32 s6, s27, 3
    s_lshl_b32 s6, s6, 10
    s_add_u32 s5, s5, s6
    s_add_u32 s5, s5, 12517376
    v_lshl_add_u32 v9, v2, 4, s5
    global_store_dwordx4 v9, v[4:7], s[40:41] sc0 sc1
    v_add_u32 v9, 8704, v9
    global_store_dwordx4 v9, v[4:7], s[40:41] sc0 sc1
    v_add_u32 v9, 8704, v9
    global_store_dwordx4 v9, v[4:7], s[40:41] sc0 sc1
    v_add_u32 v9, 8704, v9
    global_store_dwordx4 v9, v[4:7], s[40:41] sc0 sc1
    v_add_u32 v9, 8704, v9
    global_store_dwordx4 v9, v[4:7], s[40:41] sc0 sc1
    v_add_u32 v9, 8704, v9
    global_store_dwordx4 v9, v[4:7], s[40:41] sc0 sc1
    v_add_u32 v9, 8704, v9
    global_store_dwordx4 v9, v[4:7], s[40:41] sc0 sc1
    v_add_u32 v9, 8704, v9
    s_waitcnt vmcnt(0)
    s_barrier
    v_cmp_eq_u32 vcc, 0, v0
    s_nop 0
    s_and_saveexec_b64 s[12:13], vcc
    s_cbranch_execz K3_hy
    global_store_dword v8, v4, s[40:41] offset:64 sc0 sc1
K3_hy:
    s_mov_b64 exec, s[12:13]
    s_sleep 8
    s_sleep 8
    global_store_dwordx4 v3, v[4:7], s[40:41] offset:0 sc0 sc1
    global_store_dwordx4 v3, v[4:7], s[40:41] offset:1024 sc0 sc1
    global_store_dwordx4 v3, v[4:7], s[40:41] offset:2048 sc0 sc1
    global_store_dwordx4 v3, v[4:7], s[40:41] offset:3072 sc0 sc1
    v_add_u32 v3, 4096, v3
    global_store_dwordx4 v3, v[4:7], s[40:41] offset:0 sc0 sc1
    global_store_dwordx4 v3, v[4:7], s[40:41] offset:1024 sc0 sc1
    global_store_dwordx4 v3, v[4:7], s[40:41] offset:2048 sc0 sc1
    global_store_dwordx4 v3, v[4:7], s[40:41] offset:3072 sc0 sc1
    v_add_u32 v3, 4096, v3
    global_store_dwordx4 v3, v[4:7], s[40:41] offset:0 sc0 sc1
    global_store_dwordx4 v3, v[4:7], s[40:41] offset:1024 sc0 sc1
    global_store_dwordx4 v3, v[4:7], s[40:41] offset:2048 sc0 sc1
    global_store_dwordx4 v3, v[4:7], s[40:41] offset:3072 sc0 sc1
    v_add_u32 v3, 4096, v3
    global_store_dwordx4 v3, v[4:7], s[40:41] offset:0 sc0 sc1
    global_store_dwordx4 v3, v[4:7], s[40:41] offset:1024 sc0 sc1
    global_store_dwordx4 v3, v[4:7], s[40:41] offset:2048 sc0 sc1
    global_store_dwordx4 v3, v[4:7], s[40:41] offset:3072 sc0 sc1
    v_add_u32 v3, 4096, v3
    global_store_dwordx4 v3, v[4:7], s[40:41] offset:0 sc0 sc1
    global_store_dwordx4 v3, v[4:7], s[40:41] offset:1024 sc0 sc1
    global_store_dwordx4 v3, v[4:7], s[40:41] offset:2048 sc0 sc1
    global_store_dwordx4 v3, v[4:7], s[40:41] offset:3072 sc0 sc1
    v_add_u32 v3, 4096, v3
    global_store_dwordx4 v3, v[4:7], s[40:41] offset:0 sc0 sc1
    global_store_dwordx4 v3, v[4:7], s[40:41] offset:1024 sc0 sc1
    global_store_dwordx4 v3, v[4:7], s[40:41] offset:2048 sc0 sc1
    global_store_dwordx4 v3, v[4:7], s[40:41] offset:3072 sc0 sc1
    v_add_u32 v3, 4096, v3
    global_store_dwordx4 v3, v[4:7], s[40:41] offset:0 sc0 sc1
    global_store_dwordx4 v3, v[4:7], s[40:41] offset:1024 sc0 sc1
    global_store_dwordx4 v3, v[4:7], s[40:41] offset:2048 sc0 sc1
    global_store_dwordx4 v3, v[4:7], s[40:41] offset:3072 sc0 sc1
    v_add_u32 v3, 4096, v3
    s_waitcnt vmcnt(0)
    s_barrier
    v_cmp_eq_u32 vcc, 0, v0
    s_nop 0
    s_and_saveexec_b64 s[12:13], vcc
    s_cbranch_execz K3_hx
    global_store_dword v8, v4, s[40:41] sc0 sc1
K3_hx:
    s_endpgm
CODE_END:
.section .rodata,"a"
.p2align 6
.amdhsa_kernel k1_prep_kernel
  .amdhsa_next_free_vgpr 128
  .amdhsa_next_free_sgpr 96
  .amdhsa_accum_offset 128
  .amdhsa_group_segment_fixed_size 0
  .amdhsa_kernarg_size 120
  .amdhsa_user_sgpr_count 2
  .amdhsa_user_sgpr_kernarg_segment_ptr 1
  .amdhsa_system_sgpr_workgroup_id_x 1
.end_amdhsa_kernel
.p2align 6
.amdhsa_kernel k3_mlp_kernel
  .amdhsa_next_free_vgpr 256
  .amdhsa_next_free_sgpr 96
  .amdhsa_accum_offset 256
  .amdhsa_group_segment_fixed_size 0
  .amdhsa_kernarg_size 120
  .amdhsa_user_sgpr_count 2
  .amdhsa_user_sgpr_kernarg_segment_ptr 1
  .amdhsa_system_sgpr_workgroup_id_x 1
.end_amdhsa_kernel
```
